```python
import torch

def _softmax(x, axis=-1):
    return torch.softmax(x, dim=axis)
def _gelu(x):
    return torch.nn.functional.gelu(x, approximate="tanh")
def _silu(x):
    return torch.nn.functional.silu(x)
def _sigmoid(x):
    return torch.sigmoid(x)
def _layernorm(x, axis=-1, eps=1e-5):
    m = x.mean(dim=axis, keepdim=True)
    v = x.var(dim=axis, keepdim=True, unbiased=False)
    return (x - m) / torch.sqrt(v + eps)
def _scatter_add(tgt, idx, src, axis=0):
    return tgt.clone().index_add_(axis, idx, src)
def _segment_sum(src, seg, n):
    out = torch.zeros((n,) + src.shape[1:], dtype=src.dtype)
    return out.index_add_(0, seg, src)
def _pad(x, pw):
    flat = tuple(v for pair in reversed(pw) for v in pair)
    return torch.nn.functional.pad(x, flat)

kernel_name = 'sequential_preLN__spectral_gfnet__glu_gated_bilinear__prompt'

def setup_inputs():

    _w = (lambda a: (lambda t: t.to(torch.bfloat16) if t.is_floating_point() else t)(torch.as_tensor(a)))
    def _A_setup():
        B, S, D = 1, 2048, 1024
        Df = D // 2 + 1
        return {
            "x": _w((lambda *s: torch.randn(*s, dtype=torch.bfloat16) * 0.05)(B, S, D)),
            "w_r": _w((lambda *s: torch.randn(*s, dtype=torch.bfloat16) * 0.4)(S, Df) * 0.02),
            "w_i": _w((lambda *s: torch.randn(*s, dtype=torch.bfloat16) * 0.4)(S, Df) * 0.02),
        }
    _A_in = _A_setup()

    def _B_setup():
        B, S, D, F = 1, 2048, 1024, 3584
        return {
            "x": _w((lambda *s: torch.randn(*s, dtype=torch.bfloat16) * 0.05)(B, S, D)),
            "w_gate": _w((lambda *s: torch.randn(*s, dtype=torch.bfloat16) * 0.2)(D, F) * (D ** -0.5)),
            "w_up": _w((lambda *s: torch.randn(*s, dtype=torch.bfloat16) * 0.2)(D, F) * (D ** -0.5)),
            "w_down": _w((lambda *s: torch.randn(*s, dtype=torch.bfloat16) * 0.2)(F, D) * (F ** -0.5)),
        }
    _B_in = _B_setup()

    return {
        "A_x": _A_in["x"],
        "A_w_r": _A_in["w_r"],
        "A_w_i": _A_in["w_i"],
        "B_x": _B_in["x"],
        "B_w_gate": _B_in["w_gate"],
        "B_w_up": _B_in["w_up"],
        "B_w_down": _B_in["w_down"],
    }

def reference(A_x, A_w_r, A_w_i, B_x, B_w_gate, B_w_up, B_w_down):
    def _A_ref(x, w_r, w_i):
        B, S, D = x.shape
        X = (lambda x, axes=(-2,-1): torch.fft.rfft2(x.float(), dim=axes))(x, axes=(-2, -1))
        W = w_r + 1j * w_i
        X = X * W
        y = (lambda x, s, axes=(-2,-1): torch.fft.irfft2(x, s=s, dim=axes).to(torch.bfloat16))(X, (S, D), axes=(-2, -1))
        return y

    def _B_ref(x, w_gate, w_up, w_down):
        g = torch.einsum("bsd,df->bsf", x, w_gate)
        u = torch.einsum("bsd,df->bsf", x, w_up)
        h = g * u
        return torch.einsum("bsf,fd->bsd", h, w_down)

    x = A_x
    h = x + _A_ref(_layernorm(x, axis=-1), A_w_r, A_w_i)
    h2 = h + _B_ref(_layernorm(h, axis=-1), B_w_gate, B_w_up, B_w_down)
    return h2
```

```asm
; @launch grid=(256,1,1) block=(256,1,1) lds=163840
.amdgcn_target "amdgcn-amd-amdhsa--gfx950"
.text
.globl sequential_preLN__spectral_gfnet__glu_gated_bilinear__prompt_kernel
.p2align 8
.type sequential_preLN__spectral_gfnet__glu_gated_bilinear__prompt_kernel,@function
sequential_preLN__spectral_gfnet__glu_gated_bilinear__prompt_kernel:
    s_load_dwordx2 s[12:13], s[0:1], 0
    s_load_dwordx4 s[8:11], s[0:1], 64
    s_cmp_ge_u32 s2, 256
    s_cbranch_scc1 sequential_preLN__spectral_gfnet__glu_gated_bilinear__prompt_kernel_end
    v_lshrrev_b32 v3, 6, v0
    v_and_b32 v2, 15, v0
    v_readfirstlane_b32 s3, v3
    s_lshr_b32 s21, s2, 3
    s_cmp_lg_u32 s3, 0
    s_cbranch_scc1 sequential_preLN__spectral_gfnet__glu_gated_bilinear__prompt_kernel_cpf
    s_getpc_b64 s[16:17]
    s_lshl_b32 s14, s21, 4
    v_add_lshl_u32 v4, v2, s14, 7
    v_min_u32 v4, code_end-sequential_preLN__spectral_gfnet__glu_gated_bilinear__prompt_kernel-128, v4
    global_load_dword a79, v4, s[16:17]
sequential_preLN__spectral_gfnet__glu_gated_bilinear__prompt_kernel_cpf:
    v_and_b32 v1, 63, v0
    s_and_b32 s20, s2, 7
    s_lshl_b32 s22, s20, 2
    s_add_u32 s22, s22, s3
    s_lshl_b32 s22, s22, 5
    s_add_u32 s22, s22, s21
    s_lshl_b32 s22, s22, 12
    v_lshlrev_b32 v60, 4, v1
    s_lshl_b32 s23, s3, 12
    s_add_u32 s23, s23, 57344
    s_mov_b32 m0, s23
    s_mov_b32 s14, 4194304
    s_mov_b32 s15, 0x20000
    s_waitcnt lgkmcnt(0)
    buffer_load_dwordx4 v60, s[12:15], s22 offen offset:0 nt lds
    buffer_load_dwordx4 v60, s[12:15], s22 offen offset:1024 nt lds
    buffer_load_dwordx4 v60, s[12:15], s22 offen offset:2048 nt lds
    buffer_load_dwordx4 v60, s[12:15], s22 offen offset:3072 nt lds
    s_mov_b64 s[60:61], s[8:9]
    s_load_dwordx2 s[52:53], s[0:1], 8
    s_load_dwordx2 s[54:55], s[0:1], 16
    s_load_dwordx2 s[6:7], s[0:1], 32
    s_load_dwordx2 s[8:9], s[0:1], 40
    s_load_dwordx4 s[56:59], s[0:1], 48
    v_lshrrev_b32 v3, 4, v1
    s_lshl_b32 s24, s2, 2
    s_add_u32 s24, s24, s3
    s_lshl_b32 s24, s24, 6
    s_add_u32 s24, s24, 42008576
    v_add_u32 v180, s24, v60
    v_mov_b32 v62, 0
    v_mov_b32 v63, 0
    v_mov_b32 v64, 0
    v_mov_b32 v65, 0
    s_mov_b64 exec, 15
    global_store_dwordx4 v180, v[62:65], s[10:11] sc1
    s_mov_b64 exec, -1
    s_lshl_b32 s24, s20, 5
    s_add_u32 s24, s24, s21
    s_lshr_b32 s25, s2, 5
    s_lshl_b32 s25, s25, 5
    s_lshl_b32 s26, s20, 2
    s_add_u32 s25, s25, s26
    s_and_b32 s26, s21, 3
    s_add_u32 s25, s25, s26
    s_add_u32 s25, s25, 256
    s_bitcmp1_b32 s3, 0
    s_cselect_b32 s24, s25, s24
    s_lshl_b32 s24, s24, 7
    s_add_u32 s24, s24, 42074112
    v_add_u32 v180, s24, v60
    s_mov_b64 exec, 15
    global_store_dwordx4 v180, v[62:65], s[10:11] sc1
    s_mov_b64 exec, -1
    s_or_b32 s24, s2, s3
    s_cbranch_scc1 sequential_preLN__spectral_gfnet__glu_gated_bilinear__prompt_kernel_p1_nz
    v_lshrrev_b32 v110, 2, v1
    v_and_b32 v111, 3, v1
    v_lshlrev_b32 v111, 4, v111
    v_lshl_add_u32 v110, v110, 8, v111
    v_add_u32 v110, 41943040, v110
    global_store_dwordx4 v110, v[62:65], s[10:11] sc1
sequential_preLN__spectral_gfnet__glu_gated_bilinear__prompt_kernel_p1_nz:
    s_sub_u32 s24, s2, 16
    s_cmp_lt_u32 s24, 40
    s_cbranch_scc0 sequential_preLN__spectral_gfnet__glu_gated_bilinear__prompt_kernel_p1_ny
    s_cmp_lg_u32 s3, 3
    s_cbranch_scc1 sequential_preLN__spectral_gfnet__glu_gated_bilinear__prompt_kernel_p1_ny
    s_lshl_b32 s24, s2, 8
    s_add_u32 s24, s24, 41943040
    v_add_u32 v110, s24, v60
    s_mov_b64 exec, 15
    global_store_dwordx4 v110, v[62:65], s[10:11] sc1
    s_mov_b64 exec, -1
sequential_preLN__spectral_gfnet__glu_gated_bilinear__prompt_kernel_p1_ny:
    s_bfe_u32 s26, s2, 0x30003
    s_lshr_b32 s25, s2, 6
    s_lshl_b32 s28, s26, 2
    s_lshl_b32 s29, s20, 7
    s_add_u32 s28, s28, s29
    s_and_b32 s29, s3, 1
    s_lshl_b32 s29, s29, 6
    s_add_u32 s28, s28, s29
    s_mul_i32 s28, s28, 1026
    s_lshl_b32 s25, s25, 1
    s_lshr_b32 s29, s3, 1
    s_add_u32 s25, s25, s29
    s_lshl_b32 s29, s25, 7
    s_add_u32 s28, s28, s29
    v_and_b32 v174, 3, v1
    v_mul_u32_u24 v172, 1026, v174
    v_and_b32 v173, 60, v1
    v_lshl_add_u32 v172, v173, 1, v172
    v_add_u32 v172, s28, v172
    v_and_b32 v172, -4, v172
    s_waitcnt lgkmcnt(0)
    s_mov_b32 s44, s52
    s_mov_b32 s45, s53
    s_mov_b32 s46, 2101248
    s_mov_b32 s47, 0x20000
    s_mov_b32 s48, s54
    s_mov_b32 s49, s55
    s_mov_b32 s50, 2101248
    s_mov_b32 s51, 0x20000
    s_mov_b32 s32, 0
    s_mov_b32 s33, 1050624
    s_mov_b32 s34, 32832
    s_mov_b32 s35, 1083456
    s_barrier
    s_or_b32 s63, s2, s3
    s_cbranch_scc0 sequential_preLN__spectral_gfnet__glu_gated_bilinear__prompt_kernel_p1_w0
    buffer_load_dwordx3 v[182:184], v172, s[44:47], s32 offen
    buffer_load_dwordx3 v[186:188], v172, s[48:51], s32 offen
    buffer_load_dwordx3 v[190:192], v172, s[44:47], s33 offen
sequential_preLN__spectral_gfnet__glu_gated_bilinear__prompt_kernel_p1_w0:
    v_lshlrev_b32 v144, 2, v3
    v_cvt_f32_u32 v112, v144
    v_add_f32 v113, 1.0, v112
    v_add_f32 v114, 1.0, v113
    v_add_f32 v115, 1.0, v114
    v_add_f32 v116, 0x41800000, v112
    v_add_f32 v117, 0x41800000, v113
    v_add_f32 v118, 0x41800000, v114
    v_add_f32 v119, 0x41800000, v115
    v_or_b32 v144, 0, v2
    v_cvt_f32_u32 v144, v144
    v_mul_f32 v144, 0x3d000000, v144
    v_mul_f32 v120, v112, v144
    v_mul_f32 v121, v113, v144
    v_mul_f32 v122, v114, v144
    v_mul_f32 v123, v115, v144
    v_mul_f32 v124, v116, v144
    v_mul_f32 v125, v117, v144
    v_mul_f32 v126, v118, v144
    v_mul_f32 v127, v119, v144
    v_cos_f32 v128, v120
    v_cos_f32 v129, v121
    v_cos_f32 v130, v122
    v_cos_f32 v131, v123
    v_cos_f32 v132, v124
    v_cos_f32 v133, v125
    v_cos_f32 v134, v126
    v_cos_f32 v135, v127
    v_sin_f32 v136, v120
    v_sin_f32 v137, v121
    v_sin_f32 v138, v122
    v_sin_f32 v139, v123
    v_sin_f32 v140, v124
    v_sin_f32 v141, v125
    v_sin_f32 v142, v126
    v_sin_f32 v143, v127
    v_cvt_pk_bf16_f32 v4, -v136, -v137
    v_cvt_pk_bf16_f32 v5, -v138, -v139
    v_cvt_pk_bf16_f32 v6, v128, v129
    v_cvt_pk_bf16_f32 v7, v130, v131
    v_cvt_pk_bf16_f32 v8, v136, v137
    v_cvt_pk_bf16_f32 v9, v138, v139
    v_cvt_pk_bf16_f32 v10, -v140, -v141
    v_cvt_pk_bf16_f32 v11, -v142, -v143
    v_cvt_pk_bf16_f32 v12, v132, v133
    v_cvt_pk_bf16_f32 v13, v134, v135
    v_cvt_pk_bf16_f32 v14, v140, v141
    v_cvt_pk_bf16_f32 v15, v142, v143
    v_or_b32 v144, 16, v2
    v_cvt_f32_u32 v144, v144
    v_mul_f32 v144, 0x3d000000, v144
    v_mul_f32 v120, v112, v144
    v_mul_f32 v121, v113, v144
    v_mul_f32 v122, v114, v144
    v_mul_f32 v123, v115, v144
    v_mul_f32 v124, v116, v144
    v_mul_f32 v125, v117, v144
    v_mul_f32 v126, v118, v144
    v_mul_f32 v127, v119, v144
    v_cos_f32 v128, v120
    v_cos_f32 v129, v121
    v_cos_f32 v130, v122
    v_cos_f32 v131, v123
    v_cos_f32 v132, v124
    v_cos_f32 v133, v125
    v_cos_f32 v134, v126
    v_cos_f32 v135, v127
    v_sin_f32 v136, v120
    v_sin_f32 v137, v121
    v_sin_f32 v138, v122
    v_sin_f32 v139, v123
    v_sin_f32 v140, v124
    v_sin_f32 v141, v125
    v_sin_f32 v142, v126
    v_sin_f32 v143, v127
    v_cvt_pk_bf16_f32 v16, -v136, -v137
    v_cvt_pk_bf16_f32 v17, -v138, -v139
    v_cvt_pk_bf16_f32 v18, v128, v129
    v_cvt_pk_bf16_f32 v19, v130, v131
    v_cvt_pk_bf16_f32 v20, v136, v137
    v_cvt_pk_bf16_f32 v21, v138, v139
    v_cvt_pk_bf16_f32 v22, -v140, -v141
    v_cvt_pk_bf16_f32 v23, -v142, -v143
    v_cvt_pk_bf16_f32 v24, v132, v133
    v_cvt_pk_bf16_f32 v25, v134, v135
    v_cvt_pk_bf16_f32 v26, v140, v141
    v_cvt_pk_bf16_f32 v27, v142, v143
    v_or_b32 v144, 0, v2
    v_cvt_f32_u32 v144, v144
    v_mul_f32 v144, 0x3a800000, v144
    v_mul_f32 v120, v112, v144
    v_mul_f32 v121, v113, v144
    v_mul_f32 v122, v114, v144
    v_mul_f32 v123, v115, v144
    v_mul_f32 v124, v116, v144
    v_mul_f32 v125, v117, v144
    v_mul_f32 v126, v118, v144
    v_mul_f32 v127, v119, v144
    v_cos_f32 v28, v120
    v_sin_f32 v44, v120
    v_cos_f32 v29, v121
    v_sin_f32 v45, v121
    v_cos_f32 v30, v122
    v_sin_f32 v46, v122
    v_cos_f32 v31, v123
    v_sin_f32 v47, v123
    v_cos_f32 v32, v124
    v_sin_f32 v48, v124
    v_cos_f32 v33, v125
    v_sin_f32 v49, v125
    v_cos_f32 v34, v126
    v_sin_f32 v50, v126
    v_cos_f32 v35, v127
    v_sin_f32 v51, v127
    v_or_b32 v144, 16, v2
    v_cvt_f32_u32 v144, v144
    v_mul_f32 v144, 0x3a800000, v144
    v_mul_f32 v120, v112, v144
    v_mul_f32 v121, v113, v144
    v_mul_f32 v122, v114, v144
    v_mul_f32 v123, v115, v144
    v_mul_f32 v124, v116, v144
    v_mul_f32 v125, v117, v144
    v_mul_f32 v126, v118, v144
    v_mul_f32 v127, v119, v144
    v_cos_f32 v36, v120
    v_sin_f32 v52, v120
    v_cos_f32 v37, v121
    v_sin_f32 v53, v121
    v_cos_f32 v38, v122
    v_sin_f32 v54, v122
    v_cos_f32 v39, v123
    v_sin_f32 v55, v123
    v_cos_f32 v40, v124
    v_sin_f32 v56, v124
    v_cos_f32 v41, v125
    v_sin_f32 v57, v125
    v_cos_f32 v42, v126
    v_sin_f32 v58, v126
    v_cos_f32 v43, v127
    v_sin_f32 v59, v127
    v_lshrrev_b32 v178, 2, v1
    v_lshlrev_b32 v61, 6, v178
    v_lshl_add_u32 v61, v174, 3, v61
    v_add_u32 v61, s23, v61
    s_mul_i32 s24, s3, 2112
    s_add_u32 s24, s24, 114688
    v_mul_u32_u24 v178, 1056, v3
    v_lshl_add_u32 v178, v2, 3, v178
    v_sub_u32 v179, 4220, v178
    v_cmp_lt_u32 vcc, 31, v1
    s_nop 1
    v_cndmask_b32 v178, v178, v179, vcc
    v_cndmask_b32 v179, 1, -1, vcc
    v_add_u32 v178, s24, v178
    v_mov_b32 v120, 264
    v_mul_i32_i24 v120, v120, v179
    v_lshl_add_u32 v150, v179, 7, v178
    v_cmp_eq_u32 s[36:37], 0, v2
    s_and_b64 vcc, vcc, s[36:37]
    v_cndmask_b32 v179, 0, 8, vcc
    v_add_u32 v146, v178, v179
    v_add_u32 v147, v146, v120
    v_add_u32 v151, v150, v120
    v_add_u32 v148, v147, v120
    v_add_u32 v152, v151, v120
    v_add_u32 v149, v148, v120
    v_add_u32 v153, v152, v120
    v_cmp_eq_u32 vcc, 32, v1
    v_subrev_u32 v179, 2112, v146
    s_nop 0
    v_cndmask_b32 v146, v146, v179, vcc
    s_mov_b32 s16, s10
    s_mov_b32 s17, s11
    s_mov_b32 s18, 4194304
    s_mov_b32 s19, 0x20000
    s_or_b32 s63, s2, s3
    s_cbranch_scc0 sequential_preLN__spectral_gfnet__glu_gated_bilinear__prompt_kernel_p1_w1
    buffer_load_dwordx3 v[194:196], v172, s[48:51], s33 offen
    buffer_load_dwordx3 v[198:200], v172, s[44:47], s34 offen
    buffer_load_dwordx3 v[202:204], v172, s[48:51], s34 offen
    buffer_load_dwordx3 v[206:208], v172, s[44:47], s35 offen
    buffer_load_dwordx3 v[210:212], v172, s[48:51], s35 offen
sequential_preLN__spectral_gfnet__glu_gated_bilinear__prompt_kernel_p1_w1:
    v_bfe_u32 v178, v1, 2, 2
    v_mul_u32_u24 v60, 2112, v178
    v_lshl_add_u32 v60, v3, 5, v60
    v_lshl_add_u32 v60, v174, 3, v60
    s_mul_i32 s24, s3, 528
    s_add_u32 s24, s24, 114688
    v_add_u32 v60, s24, v60
    s_lshr_b32 s24, s21, 4
    s_lshl_b32 s24, s24, 7
    s_lshl_b32 s27, s20, 4
    s_add_u32 s24, s24, s27
    s_and_b32 s27, s21, 15
    s_add_u32 s24, s24, s27
    s_bfe_u32 s27, s24, 0x20002
    s_lshl_b32 s24, s24, 6
    s_mul_i32 s28, s3, 1048576
    s_add_u32 s28, s28, s24
    v_xor_b32 v178, s27, v174
    v_lshlrev_b32 v178, 4, v178
    v_lshrrev_b32 v179, 2, v1
    v_mul_u32_u24 v179, 16384, v179
    v_add_u32 v144, v179, v178
    s_lshr_b32 s62, s2, 7
    s_lshl_b32 s24, s26, 2
    s_lshl_b32 s27, s20, 7
    s_add_u32 s24, s24, s27
    s_and_b32 s27, s2, 64
    s_add_u32 s24, s24, s27
    s_lshl_b32 s27, s62, 10
    v_bfe_u32 v178, v1, 4, 1
    v_lshl_add_u32 v175, v178, 5, v174
    v_add_u32 v175, s24, v175
    v_bfe_u32 v178, v1, 3, 1
    v_lshl_add_u32 v178, v178, 10, v175
    v_sub_u32 v179, 2048, v178
    v_and_b32 v179, 2047, v179
    v_cmp_lt_u32 vcc, 31, v1
    v_and_b32 v176, 4, v1
    s_nop 0
    v_cndmask_b32 v178, v178, v179, vcc
    v_cmp_ne_u32 vcc, 0, v176
    v_mul_u32_u24 v178, 1026, v178
    v_add_u32 v178, s27, v178
    v_mov_b32 v170, s52
    v_mov_b32 v179, s54
    v_cndmask_b32 v170, v170, v179, vcc
    v_mov_b32 v171, s53
    v_mov_b32 v179, s55
    v_cndmask_b32 v171, v171, v179, vcc
    s_lshl_b32 s62, s62, 2
    s_add_u32 s62, s62, s3
    s_cmp_eq_u32 s62, 6
    s_cselect_b32 s24, -1, 0
    v_and_b32 v178, s24, v178
    v_add_co_u32 v170, vcc, v170, v178
    s_nop 1
    v_addc_co_u32 v171, vcc, 0, v171, vcc
    s_or_b32 s63, s2, s3
    s_cbranch_scc0 sequential_preLN__spectral_gfnet__glu_gated_bilinear__prompt_kernel_p1_w2
    global_load_ushort v176, v[170:171], off
sequential_preLN__spectral_gfnet__glu_gated_bilinear__prompt_kernel_p1_w2:
    s_lshl_b32 s24, s25, 6
    v_add_u32 v173, s24, v173
    s_lshr_b32 s24, s26, 2
    s_lshl_b32 s24, s24, 12
    s_lshl_b32 s27, s20, 8
    s_and_b32 s25, s27, 0x400
    s_add_u32 s27, s27, s25
    s_add_u32 s24, s24, s27
    s_and_b32 s27, s26, 3
    s_lshl_b32 s27, s27, 6
    s_add_u32 s24, s24, s27
    s_and_b32 s27, s3, 1
    s_lshl_b32 s27, s27, 10
    s_add_u32 s24, s24, s27
    v_lshlrev_b32 v177, 13, v173
    v_lshl_add_u32 v177, v174, 4, v177
    v_add_u32 v177, s24, v177
    s_or_b32 s63, s2, s3
    s_cbranch_scc1 sequential_preLN__spectral_gfnet__glu_gated_bilinear__prompt_kernel_p1_w3
    s_waitcnt vmcnt(0)
    v_mov_b32 v110, 1
    v_mov_b32 v111, 0
    global_store_dword v111, v110, s[60:61] sc1
    buffer_load_dwordx3 v[182:184], v172, s[44:47], s32 offen
    buffer_load_dwordx3 v[186:188], v172, s[48:51], s32 offen
    buffer_load_dwordx3 v[190:192], v172, s[44:47], s33 offen
    buffer_load_dwordx3 v[194:196], v172, s[48:51], s33 offen
    buffer_load_dwordx3 v[198:200], v172, s[44:47], s34 offen
    buffer_load_dwordx3 v[202:204], v172, s[48:51], s34 offen
    buffer_load_dwordx3 v[206:208], v172, s[44:47], s35 offen
    buffer_load_dwordx3 v[210:212], v172, s[48:51], s35 offen
    global_load_ushort v176, v[170:171], off
    s_branch sequential_preLN__spectral_gfnet__glu_gated_bilinear__prompt_kernel_p1_w4
sequential_preLN__spectral_gfnet__glu_gated_bilinear__prompt_kernel_p1_w3:
    s_waitcnt vmcnt(9)
sequential_preLN__spectral_gfnet__glu_gated_bilinear__prompt_kernel_p1_w4:
    ds_read_b64_tr_b16 v[62:63], v61 offset:0
    ds_read_b64_tr_b16 v[66:67], v61 offset:1024
    ds_read_b64_tr_b16 v[70:71], v61 offset:32
    ds_read_b64_tr_b16 v[74:75], v61 offset:1056
    ds_read_b64_tr_b16 v[64:65], v61 offset:2048
    ds_read_b64_tr_b16 v[68:69], v61 offset:3072
    ds_read_b64_tr_b16 v[72:73], v61 offset:2080
    ds_read_b64_tr_b16 v[76:77], v61 offset:3104
    s_waitcnt lgkmcnt(7)
    v_lshlrev_b32 v78, 16, v62
    v_and_b32 v79, 0xffff0000, v62
    v_pk_mul_f32 v[130:131], v[78:79], v[78:79]
    v_lshlrev_b32 v80, 16, v63
    v_and_b32 v81, 0xffff0000, v63
    v_pk_add_f32 v[128:129], v[80:81], v[78:79]
    v_pk_fma_f32 v[130:131], v[80:81], v[80:81], v[130:131]
    s_waitcnt lgkmcnt(6)
    v_lshlrev_b32 v82, 16, v66
    v_and_b32 v83, 0xffff0000, v66
    v_pk_add_f32 v[128:129], v[82:83], v[128:129]
    v_pk_fma_f32 v[130:131], v[82:83], v[82:83], v[130:131]
    v_lshlrev_b32 v84, 16, v67
    v_and_b32 v85, 0xffff0000, v67
    v_pk_add_f32 v[128:129], v[84:85], v[128:129]
    v_pk_fma_f32 v[130:131], v[84:85], v[84:85], v[130:131]
    s_waitcnt lgkmcnt(5)
    v_lshlrev_b32 v86, 16, v70
    v_and_b32 v87, 0xffff0000, v70
    v_pk_add_f32 v[128:129], v[86:87], v[128:129]
    v_pk_fma_f32 v[130:131], v[86:87], v[86:87], v[130:131]
    v_lshlrev_b32 v88, 16, v71
    v_and_b32 v89, 0xffff0000, v71
    v_pk_add_f32 v[128:129], v[88:89], v[128:129]
    v_pk_fma_f32 v[130:131], v[88:89], v[88:89], v[130:131]
    s_waitcnt lgkmcnt(4)
    v_lshlrev_b32 v90, 16, v74
    v_and_b32 v91, 0xffff0000, v74
    v_pk_add_f32 v[128:129], v[90:91], v[128:129]
    v_pk_fma_f32 v[130:131], v[90:91], v[90:91], v[130:131]
    v_lshlrev_b32 v92, 16, v75
    v_and_b32 v93, 0xffff0000, v75
    v_pk_add_f32 v[128:129], v[92:93], v[128:129]
    v_pk_fma_f32 v[130:131], v[92:93], v[92:93], v[130:131]
    s_waitcnt lgkmcnt(3)
    v_lshlrev_b32 v94, 16, v64
    v_and_b32 v95, 0xffff0000, v64
    v_pk_mul_f32 v[134:135], v[94:95], v[94:95]
    v_lshlrev_b32 v96, 16, v65
    v_and_b32 v97, 0xffff0000, v65
    v_pk_add_f32 v[132:133], v[96:97], v[94:95]
    v_pk_fma_f32 v[134:135], v[96:97], v[96:97], v[134:135]
    s_waitcnt lgkmcnt(2)
    v_lshlrev_b32 v98, 16, v68
    v_and_b32 v99, 0xffff0000, v68
    v_pk_add_f32 v[132:133], v[98:99], v[132:133]
    v_pk_fma_f32 v[134:135], v[98:99], v[98:99], v[134:135]
    v_lshlrev_b32 v100, 16, v69
    v_and_b32 v101, 0xffff0000, v69
    v_pk_add_f32 v[132:133], v[100:101], v[132:133]
    v_pk_fma_f32 v[134:135], v[100:101], v[100:101], v[134:135]
    s_waitcnt lgkmcnt(1)
    v_lshlrev_b32 v102, 16, v72
    v_and_b32 v103, 0xffff0000, v72
    v_pk_add_f32 v[132:133], v[102:103], v[132:133]
    v_pk_fma_f32 v[134:135], v[102:103], v[102:103], v[134:135]
    v_lshlrev_b32 v104, 16, v73
    v_and_b32 v105, 0xffff0000, v73
    v_pk_add_f32 v[132:133], v[104:105], v[132:133]
    v_pk_fma_f32 v[134:135], v[104:105], v[104:105], v[134:135]
    s_waitcnt lgkmcnt(0)
    v_lshlrev_b32 v106, 16, v76
    v_and_b32 v107, 0xffff0000, v76
    v_pk_add_f32 v[132:133], v[106:107], v[132:133]
    v_pk_fma_f32 v[134:135], v[106:107], v[106:107], v[134:135]
    v_lshlrev_b32 v108, 16, v77
    v_and_b32 v109, 0xffff0000, v77
    v_pk_add_f32 v[132:133], v[108:109], v[132:133]
    v_pk_fma_f32 v[134:135], v[108:109], v[108:109], v[134:135]
    v_add_f32 v128, v128, v129
    v_add_f32 v130, v130, v131
    v_add_f32 v132, v132, v133
    v_add_f32 v134, v134, v135
    v_permlane16_swap_b32 v128, v130
    s_nop 0
    v_permlane16_swap_b32 v132, v134
    v_add_f32 v128, v128, v130
    v_add_f32 v132, v132, v134
    s_nop 1
    v_permlane32_swap_b32 v128, v132
    v_add_f32 v128, v128, v132
    s_nop 1
    v_add_f32 v128, v128, v128 row_ror:8
    s_nop 1
    v_add_f32 v128, v128, v128 row_ror:4
    s_nop 1
    v_add_f32 v128, v128, v128 row_ror:2
    s_nop 1
    v_add_f32 v128, v128, v128 row_ror:1
    v_mul_f32 v128, 0x3a800000, v128
    s_nop 0
    v_readlane_b32 s40, v128, 0
    v_readlane_b32 s41, v128, 16
    v_readlane_b32 s42, v128, 32
    v_readlane_b32 s43, v128, 48
    v_mov_b32 v246, s41
    s_nop 0
    v_mov_b32 v247, s43
    v_fma_f32 v246, -s40, s40, v246
    v_fma_f32 v247, -s42, s42, v247
    v_max_f32 v246, 0, v246
    v_max_f32 v247, 0, v247
    v_add_f32 v246, 0x3727c5ac, v246
    v_add_f32 v247, 0x3727c5ac, v247
    v_rsq_f32 v136, v246
    v_rsq_f32 v138, v247
    v_mul_f32 v137, s40, v136
    v_mul_f32 v139, s42, v138
    v_pk_fma_f32 v[78:79], v[78:79], v[136:137], v[136:137] op_sel:[0,0,1] op_sel_hi:[1,0,1] neg_lo:[0,0,1] neg_hi:[0,0,1]
    v_pk_fma_f32 v[80:81], v[80:81], v[136:137], v[136:137] op_sel:[0,0,1] op_sel_hi:[1,0,1] neg_lo:[0,0,1] neg_hi:[0,0,1]
    v_pk_fma_f32 v[94:95], v[94:95], v[138:139], v[138:139] op_sel:[0,0,1] op_sel_hi:[1,0,1] neg_lo:[0,0,1] neg_hi:[0,0,1]
    v_pk_fma_f32 v[96:97], v[96:97], v[138:139], v[138:139] op_sel:[0,0,1] op_sel_hi:[1,0,1] neg_lo:[0,0,1] neg_hi:[0,0,1]
    v_cvt_pk_bf16_f32 v62, v78, v79
    v_cvt_pk_bf16_f32 v63, v80, v81
    v_cvt_pk_bf16_f32 v64, v94, v95
    v_cvt_pk_bf16_f32 v65, v96, v97
    v_pk_fma_f32 v[82:83], v[82:83], v[136:137], v[136:137] op_sel:[0,0,1] op_sel_hi:[1,0,1] neg_lo:[0,0,1] neg_hi:[0,0,1]
    v_pk_fma_f32 v[84:85], v[84:85], v[136:137], v[136:137] op_sel:[0,0,1] op_sel_hi:[1,0,1] neg_lo:[0,0,1] neg_hi:[0,0,1]
    v_pk_fma_f32 v[98:99], v[98:99], v[138:139], v[138:139] op_sel:[0,0,1] op_sel_hi:[1,0,1] neg_lo:[0,0,1] neg_hi:[0,0,1]
    v_pk_fma_f32 v[100:101], v[100:101], v[138:139], v[138:139] op_sel:[0,0,1] op_sel_hi:[1,0,1] neg_lo:[0,0,1] neg_hi:[0,0,1]
    v_cvt_pk_bf16_f32 v66, v82, v83
    v_cvt_pk_bf16_f32 v67, v84, v85
    v_cvt_pk_bf16_f32 v68, v98, v99
    v_cvt_pk_bf16_f32 v69, v100, v101
    v_pk_fma_f32 v[86:87], v[86:87], v[136:137], v[136:137] op_sel:[0,0,1] op_sel_hi:[1,0,1] neg_lo:[0,0,1] neg_hi:[0,0,1]
    v_pk_fma_f32 v[88:89], v[88:89], v[136:137], v[136:137] op_sel:[0,0,1] op_sel_hi:[1,0,1] neg_lo:[0,0,1] neg_hi:[0,0,1]
    v_pk_fma_f32 v[102:103], v[102:103], v[138:139], v[138:139] op_sel:[0,0,1] op_sel_hi:[1,0,1] neg_lo:[0,0,1] neg_hi:[0,0,1]
    v_pk_fma_f32 v[104:105], v[104:105], v[138:139], v[138:139] op_sel:[0,0,1] op_sel_hi:[1,0,1] neg_lo:[0,0,1] neg_hi:[0,0,1]
    v_cvt_pk_bf16_f32 v70, v86, v87
    v_cvt_pk_bf16_f32 v71, v88, v89
    v_cvt_pk_bf16_f32 v72, v102, v103
    v_cvt_pk_bf16_f32 v73, v104, v105
    v_pk_fma_f32 v[90:91], v[90:91], v[136:137], v[136:137] op_sel:[0,0,1] op_sel_hi:[1,0,1] neg_lo:[0,0,1] neg_hi:[0,0,1]
    v_pk_fma_f32 v[92:93], v[92:93], v[136:137], v[136:137] op_sel:[0,0,1] op_sel_hi:[1,0,1] neg_lo:[0,0,1] neg_hi:[0,0,1]
    v_pk_fma_f32 v[106:107], v[106:107], v[138:139], v[138:139] op_sel:[0,0,1] op_sel_hi:[1,0,1] neg_lo:[0,0,1] neg_hi:[0,0,1]
    v_pk_fma_f32 v[108:109], v[108:109], v[138:139], v[138:139] op_sel:[0,0,1] op_sel_hi:[1,0,1] neg_lo:[0,0,1] neg_hi:[0,0,1]
    v_cvt_pk_bf16_f32 v74, v90, v91
    v_cvt_pk_bf16_f32 v75, v92, v93
    v_cvt_pk_bf16_f32 v76, v106, v107
    v_cvt_pk_bf16_f32 v77, v108, v109
    s_mov_b64 s[38:39], 1
    v_mfma_f32_16x16x32_bf16 v[112:115], v[62:65], v[6:9], 0
    v_mfma_f32_16x16x32_bf16 v[116:119], v[62:65], v[4:7], 0
    v_mfma_f32_16x16x32_bf16 v[112:115], v[66:69], v[12:15], v[112:115]
    v_mfma_f32_16x16x32_bf16 v[116:119], v[66:69], v[10:13], v[116:119]
    v_mfma_f32_16x16x32_bf16 v[128:131], v[70:73], v[6:9], 0
    v_mfma_f32_16x16x32_bf16 v[132:135], v[70:73], v[4:7], 0
    v_mfma_f32_16x16x32_bf16 v[128:131], v[74:77], v[12:15], v[128:131]
    v_mfma_f32_16x16x32_bf16 v[132:135], v[74:77], v[10:13], v[132:135]
    v_mfma_f32_16x16x32_bf16 v[120:123], v[62:65], v[18:21], 0
    s_nop 1
    v_mul_f32 v246, v112, v44
    v_mul_f32 v247, v113, v45
    v_mfma_f32_16x16x32_bf16 v[124:127], v[62:65], v[16:19], 0
    v_mul_f32 v248, v114, v46
    v_mul_f32 v249, v115, v47
    v_mfma_f32_16x16x32_bf16 v[120:123], v[66:69], v[24:27], v[120:123]
    v_mul_f32 v112, v112, v28
    v_mul_f32 v113, v113, v29
    v_mfma_f32_16x16x32_bf16 v[124:127], v[66:69], v[22:25], v[124:127]
    v_mul_f32 v114, v114, v30
    v_mul_f32 v115, v115, v31
    v_mfma_f32_16x16x32_bf16 v[136:139], v[70:73], v[18:21], 0
    v_fmac_f32 v112, v116, v44
    v_fmac_f32 v113, v117, v45
    v_mfma_f32_16x16x32_bf16 v[140:143], v[70:73], v[16:19], 0
    v_fmac_f32 v114, v118, v46
    v_fmac_f32 v115, v119, v47
    v_mfma_f32_16x16x32_bf16 v[136:139], v[74:77], v[24:27], v[136:139]
    v_fma_f32 v116, v116, v28, -v246
    v_fma_f32 v117, v117, v29, -v247
    v_mfma_f32_16x16x32_bf16 v[140:143], v[74:77], v[22:25], v[140:143]
    v_fma_f32 v118, v118, v30, -v248
    v_fma_f32 v119, v119, v31, -v249
    v_pk_mul_f32 v[246:247], v[128:129], v[48:49]
    v_pk_mul_f32 v[248:249], v[130:131], v[50:51]
    v_pk_mul_f32 v[128:129], v[128:129], v[32:33]
    v_pk_mul_f32 v[130:131], v[130:131], v[34:35]
    v_pk_fma_f32 v[128:129], v[132:133], v[48:49], v[128:129]
    v_pk_fma_f32 v[130:131], v[134:135], v[50:51], v[130:131]
    v_pk_fma_f32 v[132:133], v[132:133], v[32:33], v[246:247] neg_lo:[0,0,1] neg_hi:[0,0,1]
    v_pk_fma_f32 v[134:135], v[134:135], v[34:35], v[248:249] neg_lo:[0,0,1] neg_hi:[0,0,1]
    v_cvt_pk_bf16_f32 v62, v112, v113
    v_cvt_pk_bf16_f32 v63, v114, v115
    v_cvt_pk_bf16_f32 v64, v116, v117
    v_cvt_pk_bf16_f32 v65, v118, v119
    v_cvt_pk_bf16_f32 v66, v128, v129
    v_cvt_pk_bf16_f32 v67, v130, v131
    v_cvt_pk_bf16_f32 v68, v132, v133
    v_cvt_pk_bf16_f32 v69, v134, v135
    v_mfma_f32_16x16x32_bf16 v[78:81], v[6:9], v[62:65], 0
    v_mul_f32 v246, v120, v52
    v_mul_f32 v247, v121, v53
    v_mfma_f32_16x16x32_bf16 v[82:85], v[4:7], v[62:65], 0
    v_mul_f32 v248, v122, v54
    v_mul_f32 v249, v123, v55
    v_mfma_f32_16x16x32_bf16 v[86:89], v[18:21], v[62:65], 0
    v_mul_f32 v120, v120, v36
    v_mul_f32 v121, v121, v37
    v_mfma_f32_16x16x32_bf16 v[90:93], v[16:19], v[62:65], 0
    v_mul_f32 v122, v122, v38
    v_mul_f32 v123, v123, v39
    v_mfma_f32_16x16x32_bf16 v[78:81], v[12:15], v[66:69], v[78:81]
    v_fmac_f32 v120, v124, v52
    v_fmac_f32 v121, v125, v53
    v_mfma_f32_16x16x32_bf16 v[82:85], v[10:13], v[66:69], v[82:85]
    v_fmac_f32 v122, v126, v54
    v_fmac_f32 v123, v127, v55
    v_mfma_f32_16x16x32_bf16 v[86:89], v[24:27], v[66:69], v[86:89]
    v_fma_f32 v124, v124, v36, -v246
    v_fma_f32 v125, v125, v37, -v247
    v_mfma_f32_16x16x32_bf16 v[90:93], v[22:25], v[66:69], v[90:93]
    v_fma_f32 v126, v126, v38, -v248
    v_fma_f32 v127, v127, v39, -v249
    v_pk_mul_f32 v[246:247], v[136:137], v[56:57]
    v_pk_mul_f32 v[248:249], v[138:139], v[58:59]
    v_pk_mul_f32 v[136:137], v[136:137], v[40:41]
    v_pk_mul_f32 v[138:139], v[138:139], v[42:43]
    v_pk_fma_f32 v[136:137], v[140:141], v[56:57], v[136:137]
    v_pk_fma_f32 v[138:139], v[142:143], v[58:59], v[138:139]
    v_pk_fma_f32 v[140:141], v[140:141], v[40:41], v[246:247] neg_lo:[0,0,1] neg_hi:[0,0,1]
    v_pk_fma_f32 v[142:143], v[142:143], v[42:43], v[248:249] neg_lo:[0,0,1] neg_hi:[0,0,1]
    v_cvt_pk_bf16_f32 v70, v120, v121
    v_cvt_pk_bf16_f32 v71, v122, v123
    v_cvt_pk_bf16_f32 v72, v124, v125
    v_cvt_pk_bf16_f32 v73, v126, v127
    v_cvt_pk_bf16_f32 v74, v136, v137
    v_cvt_pk_bf16_f32 v75, v138, v139
    v_cvt_pk_bf16_f32 v76, v140, v141
    v_cvt_pk_bf16_f32 v77, v142, v143
    v_mfma_f32_16x16x32_bf16 v[94:97], v[6:9], v[70:73], 0
    v_cndmask_b32 v78, v78, v86, s[38:39]
    v_cvt_pk_bf16_f32 v78, v78, v86
    v_mfma_f32_16x16x32_bf16 v[98:101], v[4:7], v[70:73], 0
    ds_write_b32 v146, v78 offset:0
    v_cvt_pk_bf16_f32 v79, v79, v87
    v_mfma_f32_16x16x32_bf16 v[102:105], v[18:21], v[70:73], 0
    ds_write_b32 v147, v79 offset:0
    v_cvt_pk_bf16_f32 v80, v80, v88
    v_mfma_f32_16x16x32_bf16 v[106:109], v[16:19], v[70:73], 0
    ds_write_b32 v148, v80 offset:0
    v_cvt_pk_bf16_f32 v81, v81, v89
    v_mfma_f32_16x16x32_bf16 v[94:97], v[12:15], v[74:77], v[94:97]
    ds_write_b32 v149, v81 offset:0
    v_cndmask_b32 v82, v82, v90, s[38:39]
    v_mfma_f32_16x16x32_bf16 v[98:101], v[10:13], v[74:77], v[98:101]
    v_cvt_pk_bf16_f32 v82, v82, -v90
    ds_write_b32 v146, v82 offset:8448
    v_mfma_f32_16x16x32_bf16 v[102:105], v[24:27], v[74:77], v[102:105]
    v_cvt_pk_bf16_f32 v83, v83, -v91
    ds_write_b32 v147, v83 offset:8448
    v_mfma_f32_16x16x32_bf16 v[106:109], v[22:25], v[74:77], v[106:109]
    v_cvt_pk_bf16_f32 v84, v84, -v92
    ds_write_b32 v148, v84 offset:8448
    v_cvt_pk_bf16_f32 v85, v85, -v93
    ds_write_b32 v149, v85 offset:8448
    s_nop 0
    v_cvt_pk_bf16_f32 v94, v94, v102
    ds_write_b32 v150, v94 offset:0
    v_cvt_pk_bf16_f32 v95, v95, v103
    ds_write_b32 v151, v95 offset:0
    v_cvt_pk_bf16_f32 v96, v96, v104
    ds_write_b32 v152, v96 offset:0
    v_cvt_pk_bf16_f32 v97, v97, v105
    ds_write_b32 v153, v97 offset:0
    v_cvt_pk_bf16_f32 v98, v98, -v106
    ds_write_b32 v150, v98 offset:8448
    v_cvt_pk_bf16_f32 v99, v99, -v107
    ds_write_b32 v151, v99 offset:8448
    v_cvt_pk_bf16_f32 v100, v100, -v108
    ds_write_b32 v152, v100 offset:8448
    v_cvt_pk_bf16_f32 v101, v101, -v109
    ds_write_b32 v153, v101 offset:8448
    s_cmp_lg_u32 s3, 0
    s_cbranch_scc1 sequential_preLN__spectral_gfnet__glu_gated_bilinear__prompt_kernel_p1_nf
    v_mov_b32 v178, 0
    global_load_dword v217, v178, s[60:61] sc1
sequential_preLN__spectral_gfnet__glu_gated_bilinear__prompt_kernel_p1_nf:
    s_waitcnt lgkmcnt(0)
    s_barrier
    ds_read_b64_tr_b16 v[78:79], v60 offset:0
    ds_read_b64_tr_b16 v[80:81], v60 offset:8448
    ds_read_b64_tr_b16 v[82:83], v60 offset:128
    ds_read_b64_tr_b16 v[84:85], v60 offset:8576
    ds_read_b64_tr_b16 v[86:87], v60 offset:264
    ds_read_b64_tr_b16 v[88:89], v60 offset:8712
    ds_read_b64_tr_b16 v[90:91], v60 offset:392
    ds_read_b64_tr_b16 v[92:93], v60 offset:8840
    s_waitcnt lgkmcnt(6)
    buffer_store_dwordx4 v[78:81], v144, s[16:19], s28 offen sc1
    s_add_u32 s28, s28, 262144
    s_waitcnt lgkmcnt(4)
    buffer_store_dwordx4 v[82:85], v144, s[16:19], s28 offen sc1
    s_add_u32 s28, s28, 262144
    s_waitcnt lgkmcnt(2)
    buffer_store_dwordx4 v[86:89], v144, s[16:19], s28 offen sc1
    s_add_u32 s28, s28, 262144
    s_waitcnt lgkmcnt(0)
    buffer_store_dwordx4 v[90:93], v144, s[16:19], s28 offen sc1
    s_add_u32 s28, s28, 262144
    s_add_u32 s36, s10, 5242880
    s_addc_u32 s37, s11, 0
    s_mov_b32 s38, 4202496
    s_mov_b32 s39, 0x20000
    s_mov_b32 s30, 0x05040100
    s_mov_b32 s31, 0x07060302
    v_lshlrev_b32 v178, 4, v174
    v_and_b32 v178, 16, v178
    s_waitcnt vmcnt(4)
    v_alignbit_b32 v182, v183, v182, v178
    v_alignbit_b32 v183, v184, v183, v178
    v_alignbit_b32 v186, v187, v186, v178
    v_alignbit_b32 v187, v188, v187, v178
    v_alignbit_b32 v190, v191, v190, v178
    v_alignbit_b32 v191, v192, v191, v178
    v_alignbit_b32 v194, v195, v194, v178
    v_alignbit_b32 v195, v196, v195, v178
    v_alignbit_b32 v198, v199, v198, v178
    v_alignbit_b32 v199, v200, v199, v178
    v_alignbit_b32 v202, v203, v202, v178
    v_alignbit_b32 v203, v204, v203, v178
    v_alignbit_b32 v206, v207, v206, v178
    v_alignbit_b32 v207, v208, v207, v178
    v_alignbit_b32 v210, v211, v210, v178
    v_alignbit_b32 v211, v212, v211, v178
    v_perm_b32 v158, v186, v182, s31
    v_perm_b32 v159, v194, v190, s31
    v_perm_b32 v160, v202, v198, s31
    v_perm_b32 v161, v210, v206, s31
    s_mov_b32 s29, 8192
    buffer_store_dwordx4 v[158:161], v177, s[36:39], s29 offen sc1
    v_perm_b32 v162, v187, v183, s30
    v_perm_b32 v163, v195, v191, s30
    v_perm_b32 v164, v203, v199, s30
    v_perm_b32 v165, v211, v207, s30
    s_mov_b32 s29, 16384
    buffer_store_dwordx4 v[162:165], v177, s[36:39], s29 offen sc1
    v_perm_b32 v166, v187, v183, s31
    v_perm_b32 v167, v195, v191, s31
    v_perm_b32 v168, v203, v199, s31
    v_perm_b32 v169, v211, v207, s31
    s_mov_b32 s29, 24576
    buffer_store_dwordx4 v[166:169], v177, s[36:39], s29 offen sc1
    v_perm_b32 v154, v186, v182, s30
    v_perm_b32 v155, v194, v190, s30
    v_perm_b32 v156, v202, v198, s30
    v_perm_b32 v157, v210, v206, s30
    s_mov_b32 s29, 0
    buffer_store_dwordx4 v[154:157], v177, s[36:39], s29 offen sc1
    s_cmp_lg_u32 s62, 6
    s_cbranch_scc1 sequential_preLN__spectral_gfnet__glu_gated_bilinear__prompt_kernel_p1_ns2
    v_bfe_u32 v178, v175, 4, 1
    v_lshlrev_b32 v170, 12, v178
    v_bfe_u32 v178, v175, 9, 1
    v_lshl_add_u32 v170, v178, 11, v170
    v_bfe_u32 v178, v175, 6, 1
    v_lshl_add_u32 v170, v178, 10, v170
    v_bfe_u32 v178, v175, 7, 2
    v_lshl_add_u32 v170, v178, 8, v170
    v_and_b32 v178, 15, v175
    v_lshl_add_u32 v170, v178, 4, v170
    s_mov_b32 s29, 0x400000
    v_lshlrev_b32 v176, 16, v176
    v_lshlrev_b32 v179, 29, v1
    v_and_b32 v179, 0x80000000, v179
    v_mov_b32 v178, v176
    s_nop 1
    v_permlane32_swap_b32 v176, v178
    v_xor_b32 v178, v178, v179
    v_add_f32 v178, v178, v176
    v_mul_f32 v178, 0.5, v178
    s_nop 1
    v_mov_b32 v179, v178 row_shl:4 row_mask:0xf bank_mask:0xf
    v_cvt_pk_bf16_f32 v158, v178, v179
    s_nop 1
    v_mov_b32 v159, v158 row_shl:8 row_mask:0xf bank_mask:0xf
    v_mov_b32 v160, v158
    v_mov_b32 v161, v159
    s_nop 0
    v_permlane16_swap_b32 v158, v160
    v_permlane16_swap_b32 v159, v161
    s_mov_b64 exec, 15
    buffer_store_dwordx4 v[158:161], v170, s[36:39], s29 offen sc1
    s_mov_b64 exec, -1
sequential_preLN__spectral_gfnet__glu_gated_bilinear__prompt_kernel_p1_ns2:
    s_and_b32 s48, s2, 7
    s_lshl_b32 s48, s48, 2
    s_bfe_u32 s49, s2, 0x20003
    s_add_u32 s48, s48, s49
    s_lshr_b32 s49, s2, 5
    s_mov_b32 s51, 0
    s_mul_i32 s50, s3, 7168
    s_and_b32 s20, s2, 7
    s_lshl_b32 s20, s20, 5
    s_lshr_b32 s21, s2, 3
    s_add_u32 s20, s20, s21
    s_lshl_b32 s21, s3, 12
    s_mul_i32 s22, s20, 16384
    s_add_u32 s22, s22, s21
    s_add_u32 s21, s21, 114688
    v_lshlrev_b32 v60, 4, v1
    s_and_b32 s25, s3, 1
    s_and_b32 s26, s3, 2
    s_xor_b32 s27, s26, 3
    s_sub_u32 s23, 512, s20
    s_cmp_eq_u32 s26, 0
    s_cselect_b32 s23, s20, s23
    s_cmp_lg_u32 s20, 0
    s_cbranch_scc1 sequential_preLN__spectral_gfnet__glu_gated_bilinear__prompt_kernel_p2_reg
    s_xor_b32 s27, s26, 1
    s_lshl_b32 s23, s26, 7
    s_sub_u32 s23, 512, s23
sequential_preLN__spectral_gfnet__glu_gated_bilinear__prompt_kernel_p2_reg:
    s_cmp_eq_u32 s25, 0
    s_cselect_b32 s28, s26, s27
    s_cselect_b32 s27, s27, s26
    s_mov_b32 s26, s28
    s_lshl_b32 s23, s23, 13
    s_mul_i32 s28, s25, 6144
    s_add_u32 s23, s23, s28
    s_xor_b32 s24, s23, 2048
    s_mov_b32 s12, s10
    s_mov_b32 s13, s11
    s_mov_b32 s14, 4194304
    s_mov_b32 s15, 0x20000
    s_add_u32 s16, s10, 5242880
    s_addc_u32 s17, s11, 0
    s_mov_b32 s18, 4202496
    s_mov_b32 s19, 0x20000
    s_add_u32 s44, s10, 10485760
    s_addc_u32 s45, s11, 0
    s_mov_b32 s46, 4194304
    s_mov_b32 s47, 0x20000
    s_lshl_b32 s28, s3, 11
    s_add_u32 s28, s28, 131072
    v_add_u32 v247, s28, v60
    s_xor_b32 s28, s3, 1
    s_lshl_b32 s28, s28, 11
    s_add_u32 s28, s28, 131072
    v_add_u32 v248, s28, v60
    s_bitcmp1_b32 s3, 0
    s_cbranch_scc0 sequential_preLN__spectral_gfnet__glu_gated_bilinear__prompt_kernel_p2_sw
    v_swap_b32 v4, v22
    v_swap_b32 v5, v23
    v_swap_b32 v6, v24
    v_swap_b32 v7, v25
    v_swap_b32 v8, v26
    v_swap_b32 v9, v27
    v_swap_b32 v28, v40
    v_swap_b32 v29, v41
    v_swap_b32 v30, v42
    v_swap_b32 v31, v43
    v_swap_b32 v44, v56
    v_swap_b32 v45, v57
    v_swap_b32 v46, v58
    v_swap_b32 v47, v59
    v_swap_b32 v10, v16
    v_swap_b32 v11, v17
    v_swap_b32 v12, v18
    v_swap_b32 v13, v19
    v_swap_b32 v14, v20
    v_swap_b32 v15, v21
    v_swap_b32 v32, v36
    v_swap_b32 v33, v37
    v_swap_b32 v34, v38
    v_swap_b32 v35, v39
    v_swap_b32 v48, v52
    v_swap_b32 v49, v53
    v_swap_b32 v50, v54
    v_swap_b32 v51, v55
sequential_preLN__spectral_gfnet__glu_gated_bilinear__prompt_kernel_p2_sw:
    s_mul_i32 s28, s25, 12288
    s_add_u32 s28, s28, 114688
    s_cmp_eq_u32 s25, 0
    s_cselect_b32 s29, 1, -1
    s_lshl_b32 s29, s29, 12
    v_bfe_u32 v251, v1, 2, 2
    v_lshl_add_u32 v250, v1, 6, s28
    v_xor_b32 v61, s26, v251
    v_lshl_add_u32 v166, v61, 4, v250
    v_add_u32 v167, s29, v166
    v_add_u32 v168, s29, v167
    v_add_u32 v169, s29, v168
    v_xor_b32 v61, s27, v251
    v_lshl_add_u32 v170, v61, 4, v250
    v_add_u32 v171, s29, v170
    v_add_u32 v172, s29, v171
    v_add_u32 v173, s29, v172
    s_bfe_u32 s28, s20, 0x10003
    s_xor_b32 s28, s28, s26
    v_bfe_u32 v251, v1, 1, 2
    v_xor_b32 v251, s28, v251
    v_lshl_add_u32 v174, v251, 4, v250
    v_add_u32 v175, s29, v174
    v_add_u32 v176, s29, v175
    v_add_u32 v177, s29, v176
    v_lshlrev_b32 v61, 2, v3
    v_cvt_f32_u32 v110, v61
    v_add_f32 v111, 1.0, v110
    v_add_f32 v112, 1.0, v111
    v_add_f32 v113, 1.0, v112
    v_add_f32 v114, 0x41800000, v110
    v_add_f32 v115, 0x41800000, v111
    v_add_f32 v116, 0x41800000, v112
    v_add_f32 v117, 0x41800000, v113
    s_lshl_b32 s28, s25, 4
    v_or_b32 v61, s28, v2
    v_cvt_f32_u32 v61, v61
    v_mul_f32 v61, 0x3a000000, v61
    s_cmp_eq_u32 s25, 0
    s_cselect_b32 s28, 0x3f800000, 0xbf800000
    s_mov_b32 s29, 0x3c800000
    s_cbranch_scc1 sequential_preLN__spectral_gfnet__glu_gated_bilinear__prompt_kernel_p2_ev
    v_swap_b32 v110, v114
    v_swap_b32 v111, v115
    v_swap_b32 v112, v116
    v_swap_b32 v113, v117
sequential_preLN__spectral_gfnet__glu_gated_bilinear__prompt_kernel_p2_ev:
    v_fma_f32 v118, v110, s29, v61
    v_fma_f32 v119, v111, s29, v61
    v_fma_f32 v120, v112, s29, v61
    v_fma_f32 v121, v113, s29, v61
    v_fma_f32 v122, v114, s29, v61
    v_fma_f32 v123, v115, s29, v61
    v_fma_f32 v124, v116, s29, v61
    v_fma_f32 v125, v117, s29, v61
    v_cos_f32 v78, v118
    v_sin_f32 v86, v118
    v_cos_f32 v79, v119
    v_sin_f32 v87, v119
    v_cos_f32 v80, v120
    v_sin_f32 v88, v120
    v_cos_f32 v81, v121
    v_sin_f32 v89, v121
    v_cos_f32 v82, v122
    v_sin_f32 v90, v122
    v_cos_f32 v83, v123
    v_sin_f32 v91, v123
    v_cos_f32 v84, v124
    v_sin_f32 v92, v124
    v_cos_f32 v85, v125
    v_sin_f32 v93, v125
    v_mul_f32 v150, s28, v78
    v_mul_f32_e64 v158, s28, -v86
    v_mul_f32 v151, s28, v79
    v_mul_f32_e64 v159, s28, -v87
    v_mul_f32 v152, s28, v80
    v_mul_f32_e64 v160, s28, -v88
    v_mul_f32 v153, s28, v81
    v_mul_f32_e64 v161, s28, -v89
    v_mul_f32 v154, s28, v82
    v_mul_f32_e64 v162, s28, -v90
    v_mul_f32 v155, s28, v83
    v_mul_f32_e64 v163, s28, -v91
    v_mul_f32 v156, s28, v84
    v_mul_f32_e64 v164, s28, -v92
    v_mul_f32 v157, s28, v85
    v_mul_f32_e64 v165, s28, -v93
    s_bfe_u32 s28, s20, 0x20001
    s_or_b32 s29, s20, s3
    s_cselect_b32 s28, s28, 4
    s_cmp_lg_u32 s28, 0
    s_cbranch_scc1 sequential_preLN__spectral_gfnet__glu_gated_bilinear__prompt_kernel_p2_q0
    v_mov_b32 v126, v4 quad_perm:[0,1,2,3] row_mask:0xf bank_mask:0xf
    v_mov_b32 v127, v5 quad_perm:[0,1,2,3] row_mask:0xf bank_mask:0xf
    v_mov_b32 v128, v6 quad_perm:[0,1,2,3] row_mask:0xf bank_mask:0xf
    v_mov_b32 v129, v7 quad_perm:[0,1,2,3] row_mask:0xf bank_mask:0xf
    v_mov_b32 v130, v8 quad_perm:[0,1,2,3] row_mask:0xf bank_mask:0xf
    v_mov_b32 v131, v9 quad_perm:[0,1,2,3] row_mask:0xf bank_mask:0xf
    v_mov_b32 v132, v10 quad_perm:[0,1,2,3] row_mask:0xf bank_mask:0xf
    v_mov_b32 v133, v11 quad_perm:[0,1,2,3] row_mask:0xf bank_mask:0xf
    v_mov_b32 v134, v12 quad_perm:[0,1,2,3] row_mask:0xf bank_mask:0xf
    v_mov_b32 v135, v13 quad_perm:[0,1,2,3] row_mask:0xf bank_mask:0xf
    v_mov_b32 v136, v14 quad_perm:[0,1,2,3] row_mask:0xf bank_mask:0xf
    v_mov_b32 v137, v15 quad_perm:[0,1,2,3] row_mask:0xf bank_mask:0xf
    v_mov_b32 v138, v16 quad_perm:[0,1,2,3] row_mask:0xf bank_mask:0xf
    v_mov_b32 v139, v17 quad_perm:[0,1,2,3] row_mask:0xf bank_mask:0xf
    v_mov_b32 v140, v18 quad_perm:[0,1,2,3] row_mask:0xf bank_mask:0xf
    v_mov_b32 v141, v19 quad_perm:[0,1,2,3] row_mask:0xf bank_mask:0xf
    v_mov_b32 v142, v20 quad_perm:[0,1,2,3] row_mask:0xf bank_mask:0xf
    v_mov_b32 v143, v21 quad_perm:[0,1,2,3] row_mask:0xf bank_mask:0xf
    v_mov_b32 v144, v22 quad_perm:[0,1,2,3] row_mask:0xf bank_mask:0xf
    v_mov_b32 v145, v23 quad_perm:[0,1,2,3] row_mask:0xf bank_mask:0xf
    v_mov_b32 v146, v24 quad_perm:[0,1,2,3] row_mask:0xf bank_mask:0xf
    v_mov_b32 v147, v25 quad_perm:[0,1,2,3] row_mask:0xf bank_mask:0xf
    v_mov_b32 v148, v26 quad_perm:[0,1,2,3] row_mask:0xf bank_mask:0xf
    v_mov_b32 v149, v27 quad_perm:[0,1,2,3] row_mask:0xf bank_mask:0xf
sequential_preLN__spectral_gfnet__glu_gated_bilinear__prompt_kernel_p2_q0:
    s_cmp_lg_u32 s28, 1
    s_cbranch_scc1 sequential_preLN__spectral_gfnet__glu_gated_bilinear__prompt_kernel_p2_q1
    v_mov_b32 v126, v4 quad_perm:[1,0,3,2] row_mask:0xf bank_mask:0xf
    v_mov_b32 v127, v5 quad_perm:[1,0,3,2] row_mask:0xf bank_mask:0xf
    v_mov_b32 v128, v6 quad_perm:[1,0,3,2] row_mask:0xf bank_mask:0xf
    v_mov_b32 v129, v7 quad_perm:[1,0,3,2] row_mask:0xf bank_mask:0xf
    v_mov_b32 v130, v8 quad_perm:[1,0,3,2] row_mask:0xf bank_mask:0xf
    v_mov_b32 v131, v9 quad_perm:[1,0,3,2] row_mask:0xf bank_mask:0xf
    v_mov_b32 v132, v10 quad_perm:[1,0,3,2] row_mask:0xf bank_mask:0xf
    v_mov_b32 v133, v11 quad_perm:[1,0,3,2] row_mask:0xf bank_mask:0xf
    v_mov_b32 v134, v12 quad_perm:[1,0,3,2] row_mask:0xf bank_mask:0xf
    v_mov_b32 v135, v13 quad_perm:[1,0,3,2] row_mask:0xf bank_mask:0xf
    v_mov_b32 v136, v14 quad_perm:[1,0,3,2] row_mask:0xf bank_mask:0xf
    v_mov_b32 v137, v15 quad_perm:[1,0,3,2] row_mask:0xf bank_mask:0xf
    v_mov_b32 v138, v16 quad_perm:[1,0,3,2] row_mask:0xf bank_mask:0xf
    v_mov_b32 v139, v17 quad_perm:[1,0,3,2] row_mask:0xf bank_mask:0xf
    v_mov_b32 v140, v18 quad_perm:[1,0,3,2] row_mask:0xf bank_mask:0xf
    v_mov_b32 v141, v19 quad_perm:[1,0,3,2] row_mask:0xf bank_mask:0xf
    v_mov_b32 v142, v20 quad_perm:[1,0,3,2] row_mask:0xf bank_mask:0xf
    v_mov_b32 v143, v21 quad_perm:[1,0,3,2] row_mask:0xf bank_mask:0xf
    v_mov_b32 v144, v22 quad_perm:[1,0,3,2] row_mask:0xf bank_mask:0xf
    v_mov_b32 v145, v23 quad_perm:[1,0,3,2] row_mask:0xf bank_mask:0xf
    v_mov_b32 v146, v24 quad_perm:[1,0,3,2] row_mask:0xf bank_mask:0xf
    v_mov_b32 v147, v25 quad_perm:[1,0,3,2] row_mask:0xf bank_mask:0xf
    v_mov_b32 v148, v26 quad_perm:[1,0,3,2] row_mask:0xf bank_mask:0xf
    v_mov_b32 v149, v27 quad_perm:[1,0,3,2] row_mask:0xf bank_mask:0xf
sequential_preLN__spectral_gfnet__glu_gated_bilinear__prompt_kernel_p2_q1:
    s_cmp_lg_u32 s28, 2
    s_cbranch_scc1 sequential_preLN__spectral_gfnet__glu_gated_bilinear__prompt_kernel_p2_q2
    v_mov_b32 v126, v4 quad_perm:[2,3,0,1] row_mask:0xf bank_mask:0xf
    v_mov_b32 v127, v5 quad_perm:[2,3,0,1] row_mask:0xf bank_mask:0xf
    v_mov_b32 v128, v6 quad_perm:[2,3,0,1] row_mask:0xf bank_mask:0xf
    v_mov_b32 v129, v7 quad_perm:[2,3,0,1] row_mask:0xf bank_mask:0xf
    v_mov_b32 v130, v8 quad_perm:[2,3,0,1] row_mask:0xf bank_mask:0xf
    v_mov_b32 v131, v9 quad_perm:[2,3,0,1] row_mask:0xf bank_mask:0xf
    v_mov_b32 v132, v10 quad_perm:[2,3,0,1] row_mask:0xf bank_mask:0xf
    v_mov_b32 v133, v11 quad_perm:[2,3,0,1] row_mask:0xf bank_mask:0xf
    v_mov_b32 v134, v12 quad_perm:[2,3,0,1] row_mask:0xf bank_mask:0xf
    v_mov_b32 v135, v13 quad_perm:[2,3,0,1] row_mask:0xf bank_mask:0xf
    v_mov_b32 v136, v14 quad_perm:[2,3,0,1] row_mask:0xf bank_mask:0xf
    v_mov_b32 v137, v15 quad_perm:[2,3,0,1] row_mask:0xf bank_mask:0xf
    v_mov_b32 v138, v16 quad_perm:[2,3,0,1] row_mask:0xf bank_mask:0xf
    v_mov_b32 v139, v17 quad_perm:[2,3,0,1] row_mask:0xf bank_mask:0xf
    v_mov_b32 v140, v18 quad_perm:[2,3,0,1] row_mask:0xf bank_mask:0xf
    v_mov_b32 v141, v19 quad_perm:[2,3,0,1] row_mask:0xf bank_mask:0xf
    v_mov_b32 v142, v20 quad_perm:[2,3,0,1] row_mask:0xf bank_mask:0xf
    v_mov_b32 v143, v21 quad_perm:[2,3,0,1] row_mask:0xf bank_mask:0xf
    v_mov_b32 v144, v22 quad_perm:[2,3,0,1] row_mask:0xf bank_mask:0xf
    v_mov_b32 v145, v23 quad_perm:[2,3,0,1] row_mask:0xf bank_mask:0xf
    v_mov_b32 v146, v24 quad_perm:[2,3,0,1] row_mask:0xf bank_mask:0xf
    v_mov_b32 v147, v25 quad_perm:[2,3,0,1] row_mask:0xf bank_mask:0xf
    v_mov_b32 v148, v26 quad_perm:[2,3,0,1] row_mask:0xf bank_mask:0xf
    v_mov_b32 v149, v27 quad_perm:[2,3,0,1] row_mask:0xf bank_mask:0xf
sequential_preLN__spectral_gfnet__glu_gated_bilinear__prompt_kernel_p2_q2:
    s_cmp_lg_u32 s28, 3
    s_cbranch_scc1 sequential_preLN__spectral_gfnet__glu_gated_bilinear__prompt_kernel_p2_q3
    v_mov_b32 v126, v4 quad_perm:[3,2,1,0] row_mask:0xf bank_mask:0xf
    v_mov_b32 v127, v5 quad_perm:[3,2,1,0] row_mask:0xf bank_mask:0xf
    v_mov_b32 v128, v6 quad_perm:[3,2,1,0] row_mask:0xf bank_mask:0xf
    v_mov_b32 v129, v7 quad_perm:[3,2,1,0] row_mask:0xf bank_mask:0xf
    v_mov_b32 v130, v8 quad_perm:[3,2,1,0] row_mask:0xf bank_mask:0xf
    v_mov_b32 v131, v9 quad_perm:[3,2,1,0] row_mask:0xf bank_mask:0xf
    v_mov_b32 v132, v10 quad_perm:[3,2,1,0] row_mask:0xf bank_mask:0xf
    v_mov_b32 v133, v11 quad_perm:[3,2,1,0] row_mask:0xf bank_mask:0xf
    v_mov_b32 v134, v12 quad_perm:[3,2,1,0] row_mask:0xf bank_mask:0xf
    v_mov_b32 v135, v13 quad_perm:[3,2,1,0] row_mask:0xf bank_mask:0xf
    v_mov_b32 v136, v14 quad_perm:[3,2,1,0] row_mask:0xf bank_mask:0xf
    v_mov_b32 v137, v15 quad_perm:[3,2,1,0] row_mask:0xf bank_mask:0xf
    v_mov_b32 v138, v16 quad_perm:[3,2,1,0] row_mask:0xf bank_mask:0xf
    v_mov_b32 v139, v17 quad_perm:[3,2,1,0] row_mask:0xf bank_mask:0xf
    v_mov_b32 v140, v18 quad_perm:[3,2,1,0] row_mask:0xf bank_mask:0xf
    v_mov_b32 v141, v19 quad_perm:[3,2,1,0] row_mask:0xf bank_mask:0xf
    v_mov_b32 v142, v20 quad_perm:[3,2,1,0] row_mask:0xf bank_mask:0xf
    v_mov_b32 v143, v21 quad_perm:[3,2,1,0] row_mask:0xf bank_mask:0xf
    v_mov_b32 v144, v22 quad_perm:[3,2,1,0] row_mask:0xf bank_mask:0xf
    v_mov_b32 v145, v23 quad_perm:[3,2,1,0] row_mask:0xf bank_mask:0xf
    v_mov_b32 v146, v24 quad_perm:[3,2,1,0] row_mask:0xf bank_mask:0xf
    v_mov_b32 v147, v25 quad_perm:[3,2,1,0] row_mask:0xf bank_mask:0xf
    v_mov_b32 v148, v26 quad_perm:[3,2,1,0] row_mask:0xf bank_mask:0xf
    v_mov_b32 v149, v27 quad_perm:[3,2,1,0] row_mask:0xf bank_mask:0xf
sequential_preLN__spectral_gfnet__glu_gated_bilinear__prompt_kernel_p2_q3:
    s_cmp_lg_u32 s28, 4
    s_cbranch_scc1 sequential_preLN__spectral_gfnet__glu_gated_bilinear__prompt_kernel_p2_q4
    v_mov_b32 v126, 0
    v_mov_b32 v127, 0
    v_mov_b32 v128, 0
    v_mov_b32 v129, 0
    v_mov_b32 v130, 0
    v_mov_b32 v131, 0
    v_mov_b32 v132, 0
    v_mov_b32 v133, 0
    v_mov_b32 v134, 0
    v_mov_b32 v135, 0
    v_mov_b32 v136, 0
    v_mov_b32 v137, 0
    v_mov_b32 v138, 0
    v_mov_b32 v139, 0
    v_mov_b32 v140, 0
    v_mov_b32 v141, 0
    v_mov_b32 v142, 0
    v_mov_b32 v143, 0
    v_mov_b32 v144, 0
    v_mov_b32 v145, 0
    v_mov_b32 v146, 0
    v_mov_b32 v147, 0
    v_mov_b32 v148, 0
    v_mov_b32 v149, 0
sequential_preLN__spectral_gfnet__glu_gated_bilinear__prompt_kernel_p2_q4:
    v_bfe_u32 v251, v1, 3, 2
    s_waitcnt vmcnt(0)
    s_cmp_lg_u32 s3, 0
    s_cbranch_scc1 sequential_preLN__spectral_gfnet__glu_gated_bilinear__prompt_kernel_p1_dd
    s_mov_b32 s63, 0x40000
sequential_preLN__spectral_gfnet__glu_gated_bilinear__prompt_kernel_p1_ip:
    v_readfirstlane_b32 s40, v217
    s_cmp_lg_u32 s40, 0
    s_cbranch_scc1 sequential_preLN__spectral_gfnet__glu_gated_bilinear__prompt_kernel_p1_dd
    s_sub_u32 s63, s63, 1
    s_cbranch_scc1 sequential_preLN__spectral_gfnet__glu_gated_bilinear__prompt_kernel_p1_dd
    v_mov_b32 v218, 0
    global_load_dword v217, v218, s[60:61] sc1
    s_waitcnt vmcnt(0)
    s_branch sequential_preLN__spectral_gfnet__glu_gated_bilinear__prompt_kernel_p1_ip
sequential_preLN__spectral_gfnet__glu_gated_bilinear__prompt_kernel_p1_dd:
    s_barrier
    s_cmp_lg_u32 s3, 0
    s_cbranch_scc1 sequential_preLN__spectral_gfnet__glu_gated_bilinear__prompt_kernel_s1_skip1
    s_lshr_b32 s63, s2, 3
    s_add_u32 s63, s63, s2
    s_and_b32 s63, s63, 15
    s_lshl_b32 s63, s63, 8
    s_add_u32 s63, s63, 41943040
    v_mov_b32 v182, s63
    v_mov_b32 v183, 1
    s_mov_b64 exec, 1
    global_atomic_add v184, v182, v183, s[10:11] sc0 sc1
    s_mov_b64 exec, -1
sequential_preLN__spectral_gfnet__glu_gated_bilinear__prompt_kernel_s1_skip1:
    v_xor_b32 v251, v1, v251
    v_and_b32 v251, 3, v251
    v_lshlrev_b32 v251, 4, v251
    v_lshrrev_b32 v61, 2, v1
    v_mul_u32_u24 v61, 131072, v61
    v_add_u32 v249, v61, v251
    s_mul_i32 s32, s3, 16384
    s_lshl_b32 s28, s20, 6
    s_add_u32 s32, s32, s28
    s_add_u32 s33, s32, 65536
    s_add_u32 s34, s32, 2097152
    s_add_u32 s35, s32, 2162688
    s_and_b32 s36, s2, 7
    s_lshl_b32 s36, s36, 2
    s_bfe_u32 s37, s2, 0x20003
    s_add_u32 s36, s36, s37
    s_and_b32 s37, s3, 1
    s_mul_i32 s37, s37, 229376
    s_mul_i32 s36, s36, 224
    s_add_u32 s36, s36, s37
    s_movk_i32 s37, 4682
    s_movk_i32 s38, 6944
    v_add_u32 v214, 0, v1
    v_mul_u32_u24 v215, s37, v214
    v_lshrrev_b32 v215, 16, v215
    v_lshl_add_u32 v214, v214, 4, s36
    v_mad_u32_u24 v214, v215, s38, v214
    v_accvgpr_write_b32 a16, v214
    v_add_u32 v214, 64, v1
    v_mul_u32_u24 v215, s37, v214
    v_lshrrev_b32 v215, 16, v215
    v_lshl_add_u32 v214, v214, 4, s36
    v_mad_u32_u24 v214, v215, s38, v214
    v_subrev_u32 v214, 1024, v214
    v_accvgpr_write_b32 a17, v214
    v_add_u32 v214, 128, v1
    v_mul_u32_u24 v215, s37, v214
    v_lshrrev_b32 v215, 16, v215
    v_lshl_add_u32 v214, v214, 4, s36
    v_mad_u32_u24 v214, v215, s38, v214
    v_subrev_u32 v214, 2048, v214
    v_accvgpr_write_b32 a18, v214
    v_add_u32 v214, 192, v1
    v_mul_u32_u24 v215, s37, v214
    v_lshrrev_b32 v215, 16, v215
    v_lshl_add_u32 v214, v214, 4, s36
    v_mad_u32_u24 v214, v215, s38, v214
    v_subrev_u32 v214, 3072, v214
    v_accvgpr_write_b32 a19, v214
    v_add_u32 v214, 256, v1
    v_mul_u32_u24 v215, s37, v214
    v_lshrrev_b32 v215, 16, v215
    v_lshl_add_u32 v214, v214, 4, s36
    v_mad_u32_u24 v214, v215, s38, v214
    v_accvgpr_write_b32 a20, v214
    v_add_u32 v214, 320, v1
    v_mul_u32_u24 v215, s37, v214
    v_lshrrev_b32 v215, 16, v215
    v_lshl_add_u32 v214, v214, 4, s36
    v_mad_u32_u24 v214, v215, s38, v214
    v_subrev_u32 v214, 1024, v214
    v_accvgpr_write_b32 a21, v214
    v_add_u32 v214, 384, v1
    v_mul_u32_u24 v215, s37, v214
    v_lshrrev_b32 v215, 16, v215
    v_lshl_add_u32 v214, v214, 4, s36
    v_mad_u32_u24 v214, v215, s38, v214
    v_subrev_u32 v214, 2048, v214
    v_accvgpr_write_b32 a22, v214
    s_cmp_lt_u32 s3, 2
    s_cselect_b32 s36, s6, s8
    s_cselect_b32 s37, s7, s9
    s_mov_b32 s38, 7340032
    s_mov_b32 s39, 0x20000
    v_accvgpr_read_b32 v214, a16
    v_accvgpr_read_b32 v215, a17
    v_accvgpr_read_b32 v216, a18
    v_accvgpr_read_b32 v217, a19
    v_accvgpr_read_b32 v218, a20
    v_accvgpr_read_b32 v219, a21
    v_accvgpr_read_b32 v220, a22
    s_mov_b32 s52, s50
    s_mov_b32 m0, s52
    s_nop 0
    buffer_load_dwordx4 v214, s[36:39], s51 offen offset:0  lds
    buffer_load_dwordx4 v215, s[36:39], s51 offen offset:1024  lds
    buffer_load_dwordx4 v216, s[36:39], s51 offen offset:2048  lds
    buffer_load_dwordx4 v217, s[36:39], s51 offen offset:3072  lds
    s_add_u32 s52, s52, 4096
    s_mov_b32 m0, s52
    s_nop 0
    buffer_load_dwordx4 v218, s[36:39], s51 offen offset:0  lds
    buffer_load_dwordx4 v219, s[36:39], s51 offen offset:1024  lds
    buffer_load_dwordx4 v220, s[36:39], s51 offen offset:2048  lds
    s_add_u32 s51, s51, 458752
    s_cmp_lg_u32 s3, 0
    s_cbranch_scc1 sequential_preLN__spectral_gfnet__glu_gated_bilinear__prompt_kernel_s1_skip2
    s_waitcnt vmcnt(7)
    v_readfirstlane_b32 s63, v184
    s_sub_u32 s63, 13, s63
    s_cbranch_scc1 sequential_preLN__spectral_gfnet__glu_gated_bilinear__prompt_kernel_s1_nb
sequential_preLN__spectral_gfnet__glu_gated_bilinear__prompt_kernel_s1_bo:
    s_sleep 2
    s_sub_u32 s63, s63, 1
    s_cbranch_scc0 sequential_preLN__spectral_gfnet__glu_gated_bilinear__prompt_kernel_s1_bo
sequential_preLN__spectral_gfnet__glu_gated_bilinear__prompt_kernel_s1_nb:
    s_mov_b32 s63, 0
    s_lshl_b32 s63, s63, 8
    s_add_u32 s63, s63, 41943040
    v_mbcnt_lo_u32_b32 v182, -1, 0
    v_lshl_add_u32 v182, v182, 8, s63
    s_mov_b32 s63, 0x40000
    s_mov_b64 exec, 65535
sequential_preLN__spectral_gfnet__glu_gated_bilinear__prompt_kernel_s1_poll:
    global_load_dword v183, v182, s[10:11] sc1
    s_waitcnt vmcnt(0)
    v_cmp_ne_u32 vcc, 16, v183
    s_sub_u32 s63, s63, 1
    s_cbranch_scc1 sequential_preLN__spectral_gfnet__glu_gated_bilinear__prompt_kernel_s1_done
    s_cbranch_vccz sequential_preLN__spectral_gfnet__glu_gated_bilinear__prompt_kernel_s1_done
    s_sleep 2
    s_branch sequential_preLN__spectral_gfnet__glu_gated_bilinear__prompt_kernel_s1_poll
sequential_preLN__spectral_gfnet__glu_gated_bilinear__prompt_kernel_s1_done:
    s_mov_b64 exec, -1
sequential_preLN__spectral_gfnet__glu_gated_bilinear__prompt_kernel_s1_skip2:
    s_barrier
    s_mov_b32 m0, s21
    s_nop 0
    buffer_load_dwordx4 v60, s[12:15], s22 offen offset:0 sc1 lds
    buffer_load_dwordx4 v60, s[12:15], s22 offen offset:1024 sc1 lds
    buffer_load_dwordx4 v60, s[12:15], s22 offen offset:2048 sc1 lds
    buffer_load_dwordx4 v60, s[12:15], s22 offen offset:3072 sc1 lds
    s_barrier
    buffer_load_dwordx4 v[62:65], v60, s[16:19], s23 offen offset:0 sc1
    buffer_load_dwordx4 v[66:69], v60, s[16:19], s23 offen offset:1024 sc1
    buffer_load_dwordx4 v[70:73], v60, s[16:19], s24 offen offset:0 sc1
    buffer_load_dwordx4 v[74:77], v60, s[16:19], s24 offen offset:1024 sc1
    s_waitcnt vmcnt(4)
    s_barrier
    ds_read_b128 v[78:81], v166
    ds_read_b128 v[82:85], v167
    ds_read_b128 v[86:89], v168
    ds_read_b128 v[90:93], v169
    ds_read_b128 v[94:97], v170
    ds_read_b128 v[98:101], v171
    ds_read_b128 v[102:105], v172
    ds_read_b128 v[106:109], v173
    s_waitcnt lgkmcnt(7)
    v_mfma_f32_16x16x32_bf16 v[182:185], v[78:81], v[6:9], 0
    v_mfma_f32_16x16x32_bf16 v[186:189], v[78:81], v[4:7], 0
    s_waitcnt lgkmcnt(6)
    v_mfma_f32_16x16x32_bf16 v[182:185], v[82:85], v[12:15], v[182:185]
    v_mfma_f32_16x16x32_bf16 v[186:189], v[82:85], v[10:13], v[186:189]
    s_waitcnt lgkmcnt(5)
    v_mfma_f32_16x16x32_bf16 v[190:193], v[86:89], v[6:9], 0
    v_mfma_f32_16x16x32_bf16 v[194:197], v[86:89], v[4:7], 0
    s_waitcnt lgkmcnt(4)
    v_mfma_f32_16x16x32_bf16 v[190:193], v[90:93], v[12:15], v[190:193]
    v_mfma_f32_16x16x32_bf16 v[194:197], v[90:93], v[10:13], v[194:197]
    s_waitcnt lgkmcnt(3)
    v_mul_f32 v118, v182, v44
    v_mfma_f32_16x16x32_bf16 v[198:201], v[94:97], v[6:9], 0
    v_mul_f32 v119, v183, v45
    v_mul_f32 v120, v184, v46
    v_mfma_f32_16x16x32_bf16 v[202:205], v[94:97], v[4:7], 0
    v_mul_f32 v121, v185, v47
    s_waitcnt lgkmcnt(2)
    v_mul_f32 v182, v182, v28
    v_mul_f32 v183, v183, v29
    v_mfma_f32_16x16x32_bf16 v[198:201], v[98:101], v[12:15], v[198:201]
    v_mul_f32 v184, v184, v30
    v_mfma_f32_16x16x32_bf16 v[202:205], v[98:101], v[10:13], v[202:205]
    v_mul_f32 v185, v185, v31
    v_fmac_f32 v182, v186, v44
    s_waitcnt lgkmcnt(1)
    v_fmac_f32 v183, v187, v45
    v_mfma_f32_16x16x32_bf16 v[206:209], v[102:105], v[6:9], 0
    v_fmac_f32 v184, v188, v46
    v_fmac_f32 v185, v189, v47
    v_mfma_f32_16x16x32_bf16 v[210:213], v[102:105], v[4:7], 0
    v_fma_f32 v186, v186, v28, -v118
    s_waitcnt lgkmcnt(0)
    v_fma_f32 v187, v187, v29, -v119
    v_fma_f32 v188, v188, v30, -v120
    v_mfma_f32_16x16x32_bf16 v[206:209], v[106:109], v[12:15], v[206:209]
    v_fma_f32 v189, v189, v31, -v121
    v_mfma_f32_16x16x32_bf16 v[210:213], v[106:109], v[10:13], v[210:213]
    v_pk_mul_f32 v[118:119], v[190:191], v[48:49]
    v_pk_mul_f32 v[120:121], v[192:193], v[50:51]
    v_pk_mul_f32 v[190:191], v[190:191], v[32:33]
    v_pk_mul_f32 v[192:193], v[192:193], v[34:35]
    v_pk_fma_f32 v[190:191], v[194:195], v[48:49], v[190:191]
    v_pk_fma_f32 v[192:193], v[196:197], v[50:51], v[192:193]
    v_pk_fma_f32 v[194:195], v[194:195], v[32:33], v[118:119] neg_lo:[0,0,1] neg_hi:[0,0,1]
    v_pk_fma_f32 v[196:197], v[196:197], v[34:35], v[120:121] neg_lo:[0,0,1] neg_hi:[0,0,1]
    v_cvt_pk_bf16_f32 v78, v182, v183
    v_cvt_pk_bf16_f32 v79, v184, v185
    v_cvt_pk_bf16_f32 v80, v186, v187
    v_cvt_pk_bf16_f32 v81, v188, v189
    v_cvt_pk_bf16_f32 v82, v190, v191
    v_cvt_pk_bf16_f32 v83, v192, v193
    v_cvt_pk_bf16_f32 v84, v194, v195
    v_cvt_pk_bf16_f32 v85, v196, v197
    v_mfma_f32_16x16x32_bf16 v[214:217], v[6:9], v[78:81], 0
    v_mul_f32 v118, v198, v44
    v_mul_f32 v119, v199, v45
    v_mfma_f32_16x16x32_bf16 v[218:221], v[4:7], v[78:81], 0
    v_mul_f32 v120, v200, v46
    v_mul_f32 v121, v201, v47
    v_mfma_f32_16x16x32_bf16 v[222:225], v[18:21], v[78:81], 0
    v_mul_f32 v198, v198, v28
    v_mul_f32 v199, v199, v29
    v_mfma_f32_16x16x32_bf16 v[226:229], v[16:19], v[78:81], 0
    v_mul_f32 v200, v200, v30
    v_mul_f32 v201, v201, v31
    v_mfma_f32_16x16x32_bf16 v[214:217], v[12:15], v[82:85], v[214:217]
    v_fmac_f32 v198, v202, v44
    v_fmac_f32 v199, v203, v45
    v_mfma_f32_16x16x32_bf16 v[218:221], v[10:13], v[82:85], v[218:221]
    v_fmac_f32 v200, v204, v46
    v_fmac_f32 v201, v205, v47
    v_mfma_f32_16x16x32_bf16 v[222:225], v[24:27], v[82:85], v[222:225]
    v_fma_f32 v202, v202, v28, -v118
    v_fma_f32 v203, v203, v29, -v119
    v_mfma_f32_16x16x32_bf16 v[226:229], v[22:25], v[82:85], v[226:229]
    v_fma_f32 v204, v204, v30, -v120
    v_fma_f32 v205, v205, v31, -v121
    v_pk_mul_f32 v[118:119], v[206:207], v[48:49]
    v_pk_mul_f32 v[120:121], v[208:209], v[50:51]
    v_pk_mul_f32 v[206:207], v[206:207], v[32:33]
    v_pk_mul_f32 v[208:209], v[208:209], v[34:35]
    v_pk_fma_f32 v[206:207], v[210:211], v[48:49], v[206:207]
    v_pk_fma_f32 v[208:209], v[212:213], v[50:51], v[208:209]
    v_pk_fma_f32 v[210:211], v[210:211], v[32:33], v[118:119] neg_lo:[0,0,1] neg_hi:[0,0,1]
    v_pk_fma_f32 v[212:213], v[212:213], v[34:35], v[120:121] neg_lo:[0,0,1] neg_hi:[0,0,1]
    v_cvt_pk_bf16_f32 v94, v198, v199
    v_cvt_pk_bf16_f32 v95, v200, v201
    v_cvt_pk_bf16_f32 v96, v202, v203
    v_cvt_pk_bf16_f32 v97, v204, v205
    v_cvt_pk_bf16_f32 v98, v206, v207
    v_cvt_pk_bf16_f32 v99, v208, v209
    v_cvt_pk_bf16_f32 v100, v210, v211
    v_cvt_pk_bf16_f32 v101, v212, v213
    v_mfma_f32_16x16x32_bf16 v[230:233], v[6:9], v[94:97], 0
    s_waitcnt vmcnt(0)
    v_lshlrev_b32 v182, 16, v62
    v_mfma_f32_16x16x32_bf16 v[234:237], v[4:7], v[94:97], 0
    v_and_b32 v184, 0xffff0000, v62
    v_lshlrev_b32 v186, 16, v63
    v_mfma_f32_16x16x32_bf16 v[238:241], v[18:21], v[94:97], 0
    v_and_b32 v188, 0xffff0000, v63
    v_lshlrev_b32 v183, 16, v64
    v_mfma_f32_16x16x32_bf16 v[242:245], v[16:19], v[94:97], 0
    v_and_b32 v185, 0xffff0000, v64
    v_lshlrev_b32 v187, 16, v65
    v_mfma_f32_16x16x32_bf16 v[230:233], v[12:15], v[98:101], v[230:233]
    v_and_b32 v189, 0xffff0000, v65
    v_mfma_f32_16x16x32_bf16 v[234:237], v[10:13], v[98:101], v[234:237]
    v_mfma_f32_16x16x32_bf16 v[238:241], v[24:27], v[98:101], v[238:241]
    v_mfma_f32_16x16x32_bf16 v[242:245], v[22:25], v[98:101], v[242:245]
    v_pk_add_f32 v[190:191], v[182:183], v[186:187]
    v_pk_add_f32 v[192:193], v[184:185], v[188:189]
    v_pk_add_f32 v[194:195], v[182:183], v[186:187] neg_lo:[0,1] neg_hi:[0,1]
    v_pk_add_f32 v[196:197], v[184:185], v[188:189] neg_lo:[0,1] neg_hi:[0,1]
    v_pk_fma_f32 v[198:199], v[194:195], v[158:159], v[190:191]
    v_pk_fma_f32 v[200:201], v[196:197], v[158:159], v[192:193]
    v_pk_fma_f32 v[190:191], v[194:195], v[158:159], v[190:191] neg_lo:[1,0,0] neg_hi:[1,0,0]
    v_pk_fma_f32 v[192:193], v[196:197], v[158:159], v[192:193] neg_lo:[1,0,0] neg_hi:[1,0,0]
    v_pk_mul_f32 v[202:203], v[194:195], v[150:151]
    v_pk_mul_f32 v[204:205], v[196:197], v[150:151]
    v_pk_mul_f32 v[206:207], v[198:199], v[214:215]
    v_pk_mul_f32 v[210:211], v[198:199], v[218:219] neg_lo:[1,0] neg_hi:[1,0]
    v_pk_mul_f32 v[118:119], v[190:191], v[230:231]
    v_pk_mul_f32 v[122:123], v[190:191], v[234:235] neg_lo:[1,0] neg_hi:[1,0]
    v_pk_fma_f32 v[206:207], v[200:201], v[218:219], v[206:207] neg_lo:[1,0,0] neg_hi:[1,0,0]
    v_pk_fma_f32 v[210:211], v[200:201], v[214:215], v[210:211] neg_lo:[1,0,0] neg_hi:[1,0,0]
    v_pk_fma_f32 v[118:119], v[192:193], v[234:235], v[118:119] neg_lo:[1,0,0] neg_hi:[1,0,0]
    v_pk_fma_f32 v[122:123], v[192:193], v[230:231], v[122:123] neg_lo:[1,0,0] neg_hi:[1,0,0]
    v_pk_fma_f32 v[206:207], v[202:203], v[234:235], v[206:207] neg_lo:[1,0,0] neg_hi:[1,0,0]
    v_pk_fma_f32 v[210:211], v[202:203], v[230:231], v[210:211] neg_lo:[1,0,0] neg_hi:[1,0,0]
    v_pk_fma_f32 v[118:119], v[202:203], v[218:219], v[118:119]
    v_pk_fma_f32 v[122:123], v[202:203], v[214:215], v[122:123]
    v_pk_fma_f32 v[206:207], v[204:205], v[230:231], v[206:207] neg_lo:[1,0,0] neg_hi:[1,0,0]
    v_pk_fma_f32 v[210:211], v[204:205], v[234:235], v[210:211]
    v_pk_fma_f32 v[118:119], v[204:205], v[214:215], v[118:119]
    v_pk_fma_f32 v[122:123], v[204:205], v[218:219], v[122:123] neg_lo:[1,0,0] neg_hi:[1,0,0]
    v_lshlrev_b32 v182, 16, v66
    v_and_b32 v184, 0xffff0000, v66
    v_lshlrev_b32 v186, 16, v67
    v_and_b32 v188, 0xffff0000, v67
    v_lshlrev_b32 v183, 16, v68
    v_and_b32 v185, 0xffff0000, v68
    v_lshlrev_b32 v187, 16, v69
    v_and_b32 v189, 0xffff0000, v69
    v_pk_add_f32 v[190:191], v[182:183], v[186:187]
    v_pk_add_f32 v[192:193], v[184:185], v[188:189]
    v_pk_add_f32 v[194:195], v[182:183], v[186:187] neg_lo:[0,1] neg_hi:[0,1]
    v_pk_add_f32 v[196:197], v[184:185], v[188:189] neg_lo:[0,1] neg_hi:[0,1]
    v_pk_fma_f32 v[198:199], v[194:195], v[160:161], v[190:191]
    v_pk_fma_f32 v[200:201], v[196:197], v[160:161], v[192:193]
    v_pk_fma_f32 v[190:191], v[194:195], v[160:161], v[190:191] neg_lo:[1,0,0] neg_hi:[1,0,0]
    v_pk_fma_f32 v[192:193], v[196:197], v[160:161], v[192:193] neg_lo:[1,0,0] neg_hi:[1,0,0]
    v_pk_mul_f32 v[202:203], v[194:195], v[152:153]
    v_pk_mul_f32 v[204:205], v[196:197], v[152:153]
    v_pk_mul_f32 v[208:209], v[198:199], v[216:217]
    v_pk_mul_f32 v[212:213], v[198:199], v[220:221] neg_lo:[1,0] neg_hi:[1,0]
    v_pk_mul_f32 v[120:121], v[190:191], v[232:233]
    v_pk_mul_f32 v[124:125], v[190:191], v[236:237] neg_lo:[1,0] neg_hi:[1,0]
    v_pk_fma_f32 v[208:209], v[200:201], v[220:221], v[208:209] neg_lo:[1,0,0] neg_hi:[1,0,0]
    v_pk_fma_f32 v[212:213], v[200:201], v[216:217], v[212:213] neg_lo:[1,0,0] neg_hi:[1,0,0]
    v_pk_fma_f32 v[120:121], v[192:193], v[236:237], v[120:121] neg_lo:[1,0,0] neg_hi:[1,0,0]
    v_pk_fma_f32 v[124:125], v[192:193], v[232:233], v[124:125] neg_lo:[1,0,0] neg_hi:[1,0,0]
    v_pk_fma_f32 v[208:209], v[202:203], v[236:237], v[208:209] neg_lo:[1,0,0] neg_hi:[1,0,0]
    v_pk_fma_f32 v[212:213], v[202:203], v[232:233], v[212:213] neg_lo:[1,0,0] neg_hi:[1,0,0]
    v_pk_fma_f32 v[120:121], v[202:203], v[220:221], v[120:121]
    v_pk_fma_f32 v[124:125], v[202:203], v[216:217], v[124:125]
    v_pk_fma_f32 v[208:209], v[204:205], v[232:233], v[208:209] neg_lo:[1,0,0] neg_hi:[1,0,0]
    v_pk_fma_f32 v[212:213], v[204:205], v[236:237], v[212:213]
    v_pk_fma_f32 v[120:121], v[204:205], v[216:217], v[120:121]
    v_pk_fma_f32 v[124:125], v[204:205], v[220:221], v[124:125] neg_lo:[1,0,0] neg_hi:[1,0,0]
    v_cvt_pk_bf16_f32 v86, v206, v207
    v_cvt_pk_bf16_f32 v87, v208, v209
    v_cvt_pk_bf16_f32 v88, v210, v211
    v_cvt_pk_bf16_f32 v89, v212, v213
    v_cvt_pk_bf16_f32 v102, v118, v119
    v_cvt_pk_bf16_f32 v103, v120, v121
    v_cvt_pk_bf16_f32 v104, v122, v123
    v_cvt_pk_bf16_f32 v105, v124, v125
    v_lshlrev_b32 v182, 16, v70
    v_and_b32 v184, 0xffff0000, v70
    v_lshlrev_b32 v186, 16, v71
    v_and_b32 v188, 0xffff0000, v71
    v_lshlrev_b32 v183, 16, v72
    v_and_b32 v185, 0xffff0000, v72
    v_lshlrev_b32 v187, 16, v73
    v_and_b32 v189, 0xffff0000, v73
    v_pk_add_f32 v[190:191], v[182:183], v[186:187]
    v_pk_add_f32 v[192:193], v[184:185], v[188:189]
    v_pk_add_f32 v[194:195], v[182:183], v[186:187] neg_lo:[0,1] neg_hi:[0,1]
    v_pk_add_f32 v[196:197], v[184:185], v[188:189] neg_lo:[0,1] neg_hi:[0,1]
    v_pk_fma_f32 v[198:199], v[194:195], v[162:163], v[190:191]
    v_pk_fma_f32 v[200:201], v[196:197], v[162:163], v[192:193]
    v_pk_fma_f32 v[190:191], v[194:195], v[162:163], v[190:191] neg_lo:[1,0,0] neg_hi:[1,0,0]
    v_pk_fma_f32 v[192:193], v[196:197], v[162:163], v[192:193] neg_lo:[1,0,0] neg_hi:[1,0,0]
    v_pk_mul_f32 v[202:203], v[194:195], v[154:155]
    v_pk_mul_f32 v[204:205], v[196:197], v[154:155]
    v_pk_mul_f32 v[206:207], v[198:199], v[222:223]
    v_pk_mul_f32 v[210:211], v[198:199], v[226:227] neg_lo:[1,0] neg_hi:[1,0]
    v_pk_mul_f32 v[118:119], v[190:191], v[238:239]
    v_pk_mul_f32 v[122:123], v[190:191], v[242:243] neg_lo:[1,0] neg_hi:[1,0]
    v_pk_fma_f32 v[206:207], v[200:201], v[226:227], v[206:207] neg_lo:[1,0,0] neg_hi:[1,0,0]
    v_pk_fma_f32 v[210:211], v[200:201], v[222:223], v[210:211] neg_lo:[1,0,0] neg_hi:[1,0,0]
    v_pk_fma_f32 v[118:119], v[192:193], v[242:243], v[118:119] neg_lo:[1,0,0] neg_hi:[1,0,0]
    v_pk_fma_f32 v[122:123], v[192:193], v[238:239], v[122:123] neg_lo:[1,0,0] neg_hi:[1,0,0]
    v_pk_fma_f32 v[206:207], v[202:203], v[242:243], v[206:207] neg_lo:[1,0,0] neg_hi:[1,0,0]
    v_pk_fma_f32 v[210:211], v[202:203], v[238:239], v[210:211] neg_lo:[1,0,0] neg_hi:[1,0,0]
    v_pk_fma_f32 v[118:119], v[202:203], v[226:227], v[118:119]
    v_pk_fma_f32 v[122:123], v[202:203], v[222:223], v[122:123]
    v_pk_fma_f32 v[206:207], v[204:205], v[238:239], v[206:207] neg_lo:[1,0,0] neg_hi:[1,0,0]
    v_pk_fma_f32 v[210:211], v[204:205], v[242:243], v[210:211]
    v_pk_fma_f32 v[118:119], v[204:205], v[222:223], v[118:119]
    v_pk_fma_f32 v[122:123], v[204:205], v[226:227], v[122:123] neg_lo:[1,0,0] neg_hi:[1,0,0]
    v_lshlrev_b32 v182, 16, v74
    v_and_b32 v184, 0xffff0000, v74
    v_lshlrev_b32 v186, 16, v75
    v_and_b32 v188, 0xffff0000, v75
    v_lshlrev_b32 v183, 16, v76
    v_and_b32 v185, 0xffff0000, v76
    v_lshlrev_b32 v187, 16, v77
    v_and_b32 v189, 0xffff0000, v77
    v_pk_add_f32 v[190:191], v[182:183], v[186:187]
    v_pk_add_f32 v[192:193], v[184:185], v[188:189]
    v_pk_add_f32 v[194:195], v[182:183], v[186:187] neg_lo:[0,1] neg_hi:[0,1]
    v_pk_add_f32 v[196:197], v[184:185], v[188:189] neg_lo:[0,1] neg_hi:[0,1]
    v_pk_fma_f32 v[198:199], v[194:195], v[164:165], v[190:191]
    v_pk_fma_f32 v[200:201], v[196:197], v[164:165], v[192:193]
    v_pk_fma_f32 v[190:191], v[194:195], v[164:165], v[190:191] neg_lo:[1,0,0] neg_hi:[1,0,0]
    v_pk_fma_f32 v[192:193], v[196:197], v[164:165], v[192:193] neg_lo:[1,0,0] neg_hi:[1,0,0]
    v_pk_mul_f32 v[202:203], v[194:195], v[156:157]
    v_pk_mul_f32 v[204:205], v[196:197], v[156:157]
    v_pk_mul_f32 v[208:209], v[198:199], v[224:225]
    v_pk_mul_f32 v[212:213], v[198:199], v[228:229] neg_lo:[1,0] neg_hi:[1,0]
    v_pk_mul_f32 v[120:121], v[190:191], v[240:241]
    v_pk_mul_f32 v[124:125], v[190:191], v[244:245] neg_lo:[1,0] neg_hi:[1,0]
    v_pk_fma_f32 v[208:209], v[200:201], v[228:229], v[208:209] neg_lo:[1,0,0] neg_hi:[1,0,0]
    v_pk_fma_f32 v[212:213], v[200:201], v[224:225], v[212:213] neg_lo:[1,0,0] neg_hi:[1,0,0]
    v_pk_fma_f32 v[120:121], v[192:193], v[244:245], v[120:121] neg_lo:[1,0,0] neg_hi:[1,0,0]
    v_pk_fma_f32 v[124:125], v[192:193], v[240:241], v[124:125] neg_lo:[1,0,0] neg_hi:[1,0,0]
    v_pk_fma_f32 v[208:209], v[202:203], v[244:245], v[208:209] neg_lo:[1,0,0] neg_hi:[1,0,0]
    v_pk_fma_f32 v[212:213], v[202:203], v[240:241], v[212:213] neg_lo:[1,0,0] neg_hi:[1,0,0]
    v_pk_fma_f32 v[120:121], v[202:203], v[228:229], v[120:121]
    v_pk_fma_f32 v[124:125], v[202:203], v[224:225], v[124:125]
    v_pk_fma_f32 v[208:209], v[204:205], v[240:241], v[208:209] neg_lo:[1,0,0] neg_hi:[1,0,0]
    v_pk_fma_f32 v[212:213], v[204:205], v[244:245], v[212:213]
    v_pk_fma_f32 v[120:121], v[204:205], v[224:225], v[120:121]
    v_pk_fma_f32 v[124:125], v[204:205], v[228:229], v[124:125] neg_lo:[1,0,0] neg_hi:[1,0,0]
    v_cvt_pk_bf16_f32 v90, v206, v207
    v_cvt_pk_bf16_f32 v91, v208, v209
    v_cvt_pk_bf16_f32 v92, v210, v211
    v_cvt_pk_bf16_f32 v93, v212, v213
    v_cvt_pk_bf16_f32 v106, v118, v119
    v_cvt_pk_bf16_f32 v107, v120, v121
    v_cvt_pk_bf16_f32 v108, v122, v123
    v_cvt_pk_bf16_f32 v109, v124, v125
    v_mfma_f32_16x16x32_bf16 v[198:201], v[102:105], v[6:9], 0
    v_mfma_f32_16x16x32_bf16 v[202:205], v[102:105], v[4:7], 0
    v_mfma_f32_16x16x32_bf16 v[198:201], v[106:109], v[12:15], v[198:201]
    v_mfma_f32_16x16x32_bf16 v[202:205], v[106:109], v[10:13], v[202:205]
    v_mfma_f32_16x16x32_bf16 v[206:209], v[102:105], v[18:21], 0
    v_mfma_f32_16x16x32_bf16 v[210:213], v[102:105], v[16:19], 0
    v_mfma_f32_16x16x32_bf16 v[206:209], v[106:109], v[24:27], v[206:209]
    v_mfma_f32_16x16x32_bf16 v[210:213], v[106:109], v[22:25], v[210:213]
    v_mfma_f32_16x16x32_bf16 v[182:185], v[86:89], v[6:9], 0
    s_nop 1
    v_mul_f32 v118, v198, v44
    v_mul_f32 v119, v199, v45
    v_mfma_f32_16x16x32_bf16 v[186:189], v[86:89], v[4:7], 0
    v_mul_f32 v120, v200, v46
    v_mul_f32 v121, v201, v47
    v_mfma_f32_16x16x32_bf16 v[182:185], v[90:93], v[12:15], v[182:185]
    v_mul_f32 v198, v198, v28
    v_mul_f32 v199, v199, v29
    v_mfma_f32_16x16x32_bf16 v[186:189], v[90:93], v[10:13], v[186:189]
    v_mul_f32 v200, v200, v30
    v_mul_f32 v201, v201, v31
    v_mfma_f32_16x16x32_bf16 v[190:193], v[86:89], v[18:21], 0
    v_fmac_f32 v198, v202, v44
    v_fmac_f32 v199, v203, v45
    v_mfma_f32_16x16x32_bf16 v[194:197], v[86:89], v[16:19], 0
    v_fmac_f32 v200, v204, v46
    v_fmac_f32 v201, v205, v47
    v_mfma_f32_16x16x32_bf16 v[190:193], v[90:93], v[24:27], v[190:193]
    v_fma_f32 v202, v202, v28, -v118
    v_fma_f32 v203, v203, v29, -v119
    v_mfma_f32_16x16x32_bf16 v[194:197], v[90:93], v[22:25], v[194:197]
    v_fma_f32 v204, v204, v30, -v120
    v_fma_f32 v205, v205, v31, -v121
    v_pk_mul_f32 v[118:119], v[206:207], v[52:53]
    v_pk_mul_f32 v[120:121], v[208:209], v[54:55]
    v_pk_mul_f32 v[206:207], v[206:207], v[36:37]
    v_pk_mul_f32 v[208:209], v[208:209], v[38:39]
    v_pk_fma_f32 v[206:207], v[210:211], v[52:53], v[206:207]
    v_pk_fma_f32 v[208:209], v[212:213], v[54:55], v[208:209]
    v_pk_fma_f32 v[210:211], v[210:211], v[36:37], v[118:119] neg_lo:[0,0,1] neg_hi:[0,0,1]
    v_pk_fma_f32 v[212:213], v[212:213], v[38:39], v[120:121] neg_lo:[0,0,1] neg_hi:[0,0,1]
    v_cvt_pk_bf16_f32 v94, v198, v199
    v_cvt_pk_bf16_f32 v95, v200, v201
    v_cvt_pk_bf16_f32 v96, v202, v203
    v_cvt_pk_bf16_f32 v97, v204, v205
    v_cvt_pk_bf16_f32 v98, v206, v207
    v_cvt_pk_bf16_f32 v99, v208, v209
    v_cvt_pk_bf16_f32 v100, v210, v211
    v_cvt_pk_bf16_f32 v101, v212, v213
    ds_write_b128 v247, v[94:97] offset:0
    ds_write_b128 v247, v[98:101] offset:1024
    v_pk_mul_f32 v[118:119], v[182:183], v[44:45]
    v_pk_mul_f32 v[120:121], v[184:185], v[46:47]
    v_pk_mul_f32 v[182:183], v[182:183], v[28:29]
    v_pk_mul_f32 v[184:185], v[184:185], v[30:31]
    v_pk_fma_f32 v[182:183], v[186:187], v[44:45], v[182:183]
    v_pk_fma_f32 v[184:185], v[188:189], v[46:47], v[184:185]
    v_pk_fma_f32 v[186:187], v[186:187], v[28:29], v[118:119] neg_lo:[0,0,1] neg_hi:[0,0,1]
    v_pk_fma_f32 v[188:189], v[188:189], v[30:31], v[120:121] neg_lo:[0,0,1] neg_hi:[0,0,1]
    v_cvt_pk_bf16_f32 v78, v182, v183
    v_cvt_pk_bf16_f32 v79, v184, v185
    v_cvt_pk_bf16_f32 v80, v186, v187
    v_cvt_pk_bf16_f32 v81, v188, v189
    v_pk_mul_f32 v[118:119], v[190:191], v[52:53]
    v_pk_mul_f32 v[120:121], v[192:193], v[54:55]
    v_pk_mul_f32 v[190:191], v[190:191], v[36:37]
    v_pk_mul_f32 v[192:193], v[192:193], v[38:39]
    v_pk_fma_f32 v[190:191], v[194:195], v[52:53], v[190:191]
    v_pk_fma_f32 v[192:193], v[196:197], v[54:55], v[192:193]
    v_pk_fma_f32 v[194:195], v[194:195], v[36:37], v[118:119] neg_lo:[0,0,1] neg_hi:[0,0,1]
    v_pk_fma_f32 v[196:197], v[196:197], v[38:39], v[120:121] neg_lo:[0,0,1] neg_hi:[0,0,1]
    v_cvt_pk_bf16_f32 v82, v190, v191
    v_cvt_pk_bf16_f32 v83, v192, v193
    v_cvt_pk_bf16_f32 v84, v194, v195
    v_cvt_pk_bf16_f32 v85, v196, v197
    s_waitcnt lgkmcnt(0)
    s_barrier
    ds_read_b128 v[86:89], v248 offset:1024
    ds_read_b128 v[90:93], v248 offset:0
    v_mfma_f32_16x16x32_bf16 v[214:217], v[128:131], v[78:81], 0
    v_add_u32 v60, s21, v60
    v_mfma_f32_16x16x32_bf16 v[218:221], v[126:129], v[78:81], 0
    s_mul_i32 s28, s3, 3072
    v_mfma_f32_16x16x32_bf16 v[222:225], v[140:143], v[78:81], 0
    v_subrev_u32 v60, s28, v60
    v_mfma_f32_16x16x32_bf16 v[226:229], v[138:141], v[78:81], 0
    v_mfma_f32_16x16x32_bf16 v[230:233], v[128:131], v[82:85], 0
    v_mfma_f32_16x16x32_bf16 v[234:237], v[126:129], v[82:85], 0
    v_mfma_f32_16x16x32_bf16 v[238:241], v[140:143], v[82:85], 0
    v_mfma_f32_16x16x32_bf16 v[242:245], v[138:141], v[82:85], 0
    s_waitcnt lgkmcnt(1)
    v_mfma_f32_16x16x32_bf16 v[214:217], v[134:137], v[86:89], v[214:217]
    v_mfma_f32_16x16x32_bf16 v[218:221], v[132:135], v[86:89], v[218:221]
    v_mfma_f32_16x16x32_bf16 v[222:225], v[146:149], v[86:89], v[222:225]
    v_mfma_f32_16x16x32_bf16 v[226:229], v[144:147], v[86:89], v[226:229]
    s_waitcnt lgkmcnt(0)
    v_mfma_f32_16x16x32_bf16 v[230:233], v[134:137], v[90:93], v[230:233]
    v_mfma_f32_16x16x32_bf16 v[234:237], v[132:135], v[90:93], v[234:237]
    v_mfma_f32_16x16x32_bf16 v[238:241], v[146:149], v[90:93], v[238:241]
    v_mfma_f32_16x16x32_bf16 v[242:245], v[144:147], v[90:93], v[242:245]
    s_nop 0
    v_cvt_pk_bf16_f32 v62, v214, -v218
    v_cvt_pk_bf16_f32 v63, v215, -v219
    v_cvt_pk_bf16_f32 v64, v216, -v220
    v_cvt_pk_bf16_f32 v65, v217, -v221
    ds_write_b128 v174, v[62:65]
    v_cvt_pk_bf16_f32 v66, v222, -v226
    v_cvt_pk_bf16_f32 v67, v223, -v227
    v_cvt_pk_bf16_f32 v68, v224, -v228
    v_cvt_pk_bf16_f32 v69, v225, -v229
    ds_write_b128 v175, v[66:69]
    v_cvt_pk_bf16_f32 v70, v230, -v234
    v_cvt_pk_bf16_f32 v71, v231, -v235
    v_cvt_pk_bf16_f32 v72, v232, -v236
    v_cvt_pk_bf16_f32 v73, v233, -v237
    ds_write_b128 v176, v[70:73]
    v_cvt_pk_bf16_f32 v74, v238, -v242
    v_cvt_pk_bf16_f32 v75, v239, -v243
    v_cvt_pk_bf16_f32 v76, v240, -v244
    v_cvt_pk_bf16_f32 v77, v241, -v245
    ds_write_b128 v177, v[74:77]
    s_waitcnt lgkmcnt(0)
    s_barrier
    ds_read_b128 v[214:217], v60 offset:0
    ds_read_b128 v[218:221], v60 offset:4096
    ds_read_b128 v[222:225], v60 offset:8192
    ds_read_b128 v[226:229], v60 offset:12288
    s_waitcnt lgkmcnt(3)
    buffer_store_dwordx4 v[214:217], v249, s[44:47], s32 offen sc1
    s_waitcnt lgkmcnt(2)
    buffer_store_dwordx4 v[218:221], v249, s[44:47], s33 offen sc1
    s_waitcnt lgkmcnt(1)
    buffer_store_dwordx4 v[222:225], v249, s[44:47], s34 offen sc1
    s_waitcnt lgkmcnt(0)
    buffer_store_dwordx4 v[226:229], v249, s[44:47], s35 offen sc1
    s_bitcmp1_b32 s3, 0
    s_cbranch_scc0 sequential_preLN__spectral_gfnet__glu_gated_bilinear__prompt_kernel_p3_sw
    v_swap_b32 v4, v22
    v_swap_b32 v5, v23
    v_swap_b32 v6, v24
    v_swap_b32 v7, v25
    v_swap_b32 v8, v26
    v_swap_b32 v9, v27
    v_swap_b32 v28, v40
    v_swap_b32 v29, v41
    v_swap_b32 v30, v42
    v_swap_b32 v31, v43
    v_swap_b32 v44, v56
    v_swap_b32 v45, v57
    v_swap_b32 v46, v58
    v_swap_b32 v47, v59
    v_swap_b32 v10, v16
    v_swap_b32 v11, v17
    v_swap_b32 v12, v18
    v_swap_b32 v13, v19
    v_swap_b32 v14, v20
    v_swap_b32 v15, v21
    v_swap_b32 v32, v36
    v_swap_b32 v33, v37
    v_swap_b32 v34, v38
    v_swap_b32 v35, v39
    v_swap_b32 v48, v52
    v_swap_b32 v49, v53
    v_swap_b32 v50, v54
    v_swap_b32 v51, v55
sequential_preLN__spectral_gfnet__glu_gated_bilinear__prompt_kernel_p3_sw:
    s_and_b32 s20, s2, 7
    s_lshr_b32 s21, s2, 3
    s_lshl_b32 s22, s20, 7
    s_lshl_b32 s23, s3, 5
    s_add_u32 s22, s22, s23
    s_add_u32 s22, s22, s21
    s_lshl_b32 s22, s22, 12
    v_lshlrev_b32 v61, 6, v2
    v_lshl_add_u32 v61, v3, 4, v61
    s_lshl_b32 s23, s3, 12
    s_add_u32 s23, s23, 57344
    v_lshlrev_b32 v223, 6, v2
    v_lshl_add_u32 v223, v3, 3, v223
    v_add_u32 v223, s23, v223
    ds_read_b64 v[62:63], v223 offset:0
    ds_read_b64 v[64:65], v223 offset:32
    ds_read_b64 v[66:67], v223 offset:1024
    ds_read_b64 v[68:69], v223 offset:1056
    ds_read_b64 v[70:71], v223 offset:2048
    ds_read_b64 v[72:73], v223 offset:2080
    ds_read_b64 v[74:75], v223 offset:3072
    ds_read_b64 v[76:77], v223 offset:3104
    s_lshl_b32 s23, s3, 12
    s_mul_i32 s25, s2, 16384
    s_add_u32 s24, s25, s23
    s_add_u32 s23, s23, 114688
    v_lshlrev_b32 v60, 4, v1
    s_add_u32 s12, s10, 10485760
    s_addc_u32 s13, s11, 0
    s_mov_b32 s14, 4194304
    s_mov_b32 s15, 0x20000
    s_add_u32 s16, s10, 20971520
    s_addc_u32 s17, s11, 0
    s_mov_b32 s18, 4194304
    s_mov_b32 s19, 0x20000
    v_and_b32 v223, 1, v3
    v_cvt_f32_u32 v224, v223
    v_mul_u32_u24 v223, 7, v223
    v_lshl_add_u32 v223, v3, 3, v223
    v_cvt_f32_u32 v86, v223
    v_fma_f32 v224, v224, -2.0, 1.0
    v_add_f32 v87, v86, v224
    v_add_f32 v88, v87, v224
    v_add_f32 v89, v88, v224
    v_add_f32 v90, v89, v224
    v_add_f32 v91, v90, v224
    v_add_f32 v92, v91, v224
    v_add_f32 v93, v92, v224
    v_lshrrev_b32 v223, 1, v3
    v_cvt_f32_u32 v224, v223
    v_fma_f32 v220, v224, 2.0, -1.0
    s_mov_b32 s26, 0x35000000
    v_mul_f32 v220, s26, v220
    v_or_b32 v222, 0, v2
    v_cvt_f32_u32 v222, v222
    v_mul_f32 v222, 0x3d000000, v222
    v_mul_f32 v94, v86, v222
    v_mul_f32 v95, v87, v222
    v_mul_f32 v96, v88, v222
    v_mul_f32 v97, v89, v222
    v_mul_f32 v98, v90, v222
    v_mul_f32 v99, v91, v222
    v_mul_f32 v100, v92, v222
    v_mul_f32 v101, v93, v222
    v_cos_f32 v102, v94
    v_cos_f32 v103, v95
    v_cos_f32 v104, v96
    v_cos_f32 v105, v97
    v_cos_f32 v106, v98
    v_cos_f32 v107, v99
    v_cos_f32 v108, v100
    v_cos_f32 v109, v101
    v_sin_f32 v110, v94
    v_sin_f32 v111, v95
    v_sin_f32 v112, v96
    v_sin_f32 v113, v97
    v_sin_f32 v114, v98
    v_sin_f32 v115, v99
    v_sin_f32 v116, v100
    v_sin_f32 v117, v101
    v_pk_mul_f32 v[94:95], v[110:111], v[220:221] op_sel_hi:[1,0]
    v_pk_mul_f32 v[96:97], v[102:103], v[220:221] op_sel_hi:[1,0]
    v_pk_mul_f32 v[102:103], v[102:103], s[26:27] op_sel_hi:[1,0]
    v_pk_mul_f32 v[110:111], v[110:111], s[26:27] op_sel_hi:[1,0]
    v_cvt_pk_bf16_f32 v118, v102, v94
    v_cvt_pk_bf16_f32 v122, -v110, v96
    v_cvt_pk_bf16_f32 v119, v103, v95
    v_cvt_pk_bf16_f32 v123, -v111, v97
    v_pk_mul_f32 v[94:95], v[112:113], v[220:221] op_sel_hi:[1,0]
    v_pk_mul_f32 v[96:97], v[104:105], v[220:221] op_sel_hi:[1,0]
    v_pk_mul_f32 v[104:105], v[104:105], s[26:27] op_sel_hi:[1,0]
    v_pk_mul_f32 v[112:113], v[112:113], s[26:27] op_sel_hi:[1,0]
    v_cvt_pk_bf16_f32 v120, v104, v94
    v_cvt_pk_bf16_f32 v124, -v112, v96
    v_cvt_pk_bf16_f32 v121, v105, v95
    v_cvt_pk_bf16_f32 v125, -v113, v97
    v_pk_mul_f32 v[94:95], v[114:115], v[220:221] op_sel_hi:[1,0]
    v_pk_mul_f32 v[96:97], v[106:107], v[220:221] op_sel_hi:[1,0]
    v_pk_mul_f32 v[106:107], v[106:107], s[26:27] op_sel_hi:[1,0]
    v_pk_mul_f32 v[114:115], v[114:115], s[26:27] op_sel_hi:[1,0]
    v_cvt_pk_bf16_f32 v126, v106, v94
    v_cvt_pk_bf16_f32 v130, -v114, v96
    v_cvt_pk_bf16_f32 v127, v107, v95
    v_cvt_pk_bf16_f32 v131, -v115, v97
    v_pk_mul_f32 v[94:95], v[116:117], v[220:221] op_sel_hi:[1,0]
    v_pk_mul_f32 v[96:97], v[108:109], v[220:221] op_sel_hi:[1,0]
    v_pk_mul_f32 v[108:109], v[108:109], s[26:27] op_sel_hi:[1,0]
    v_pk_mul_f32 v[116:117], v[116:117], s[26:27] op_sel_hi:[1,0]
    v_cvt_pk_bf16_f32 v128, v108, v94
    v_cvt_pk_bf16_f32 v132, -v116, v96
    v_cvt_pk_bf16_f32 v129, v109, v95
    v_cvt_pk_bf16_f32 v133, -v117, v97
    v_or_b32 v222, 16, v2
    v_cvt_f32_u32 v222, v222
    v_mul_f32 v222, 0x3d000000, v222
    v_mul_f32 v94, v86, v222
    v_mul_f32 v95, v87, v222
    v_mul_f32 v96, v88, v222
    v_mul_f32 v97, v89, v222
    v_mul_f32 v98, v90, v222
    v_mul_f32 v99, v91, v222
    v_mul_f32 v100, v92, v222
    v_mul_f32 v101, v93, v222
    v_cos_f32 v102, v94
    v_cos_f32 v103, v95
    v_cos_f32 v104, v96
    v_cos_f32 v105, v97
    v_cos_f32 v106, v98
    v_cos_f32 v107, v99
    v_cos_f32 v108, v100
    v_cos_f32 v109, v101
    v_sin_f32 v110, v94
    v_sin_f32 v111, v95
    v_sin_f32 v112, v96
    v_sin_f32 v113, v97
    v_sin_f32 v114, v98
    v_sin_f32 v115, v99
    v_sin_f32 v116, v100
    v_sin_f32 v117, v101
    s_waitcnt vmcnt(0)
    s_barrier
    s_cmp_lg_u32 s3, 0
    s_cbranch_scc1 sequential_preLN__spectral_gfnet__glu_gated_bilinear__prompt_kernel_s2_skip1
    s_lshr_b32 s63, s2, 3
    s_add_u32 s63, s63, s2
    s_and_b32 s63, s63, 15
    s_add_u32 s63, s63, 16
    s_lshl_b32 s63, s63, 8
    s_add_u32 s63, s63, 41943040
    v_mov_b32 v156, s63
    v_mov_b32 v157, 1
    s_mov_b64 exec, 1
    global_atomic_add v158, v156, v157, s[10:11] sc0 sc1
    s_mov_b64 exec, -1
sequential_preLN__spectral_gfnet__glu_gated_bilinear__prompt_kernel_s2_skip1:
    v_pk_mul_f32 v[94:95], v[110:111], v[220:221] op_sel_hi:[1,0]
    v_pk_mul_f32 v[96:97], v[102:103], v[220:221] op_sel_hi:[1,0]
    v_pk_mul_f32 v[102:103], v[102:103], s[26:27] op_sel_hi:[1,0]
    v_pk_mul_f32 v[110:111], v[110:111], s[26:27] op_sel_hi:[1,0]
    v_cvt_pk_bf16_f32 v134, v102, v94
    v_cvt_pk_bf16_f32 v138, -v110, v96
    v_cvt_pk_bf16_f32 v135, v103, v95
    v_cvt_pk_bf16_f32 v139, -v111, v97
    v_pk_mul_f32 v[94:95], v[112:113], v[220:221] op_sel_hi:[1,0]
    v_pk_mul_f32 v[96:97], v[104:105], v[220:221] op_sel_hi:[1,0]
    v_pk_mul_f32 v[104:105], v[104:105], s[26:27] op_sel_hi:[1,0]
    v_pk_mul_f32 v[112:113], v[112:113], s[26:27] op_sel_hi:[1,0]
    v_cvt_pk_bf16_f32 v136, v104, v94
    v_cvt_pk_bf16_f32 v140, -v112, v96
    v_cvt_pk_bf16_f32 v137, v105, v95
    v_cvt_pk_bf16_f32 v141, -v113, v97
    v_pk_mul_f32 v[94:95], v[114:115], v[220:221] op_sel_hi:[1,0]
    v_pk_mul_f32 v[96:97], v[106:107], v[220:221] op_sel_hi:[1,0]
    v_pk_mul_f32 v[106:107], v[106:107], s[26:27] op_sel_hi:[1,0]
    v_pk_mul_f32 v[114:115], v[114:115], s[26:27] op_sel_hi:[1,0]
    v_cvt_pk_bf16_f32 v142, v106, v94
    v_cvt_pk_bf16_f32 v146, -v114, v96
    v_cvt_pk_bf16_f32 v143, v107, v95
    v_cvt_pk_bf16_f32 v147, -v115, v97
    v_pk_mul_f32 v[94:95], v[116:117], v[220:221] op_sel_hi:[1,0]
    v_pk_mul_f32 v[96:97], v[108:109], v[220:221] op_sel_hi:[1,0]
    v_pk_mul_f32 v[108:109], v[108:109], s[26:27] op_sel_hi:[1,0]
    v_pk_mul_f32 v[116:117], v[116:117], s[26:27] op_sel_hi:[1,0]
    v_cvt_pk_bf16_f32 v144, v108, v94
    v_cvt_pk_bf16_f32 v148, -v116, v96
    v_cvt_pk_bf16_f32 v145, v109, v95
    v_cvt_pk_bf16_f32 v149, -v117, v97
    s_waitcnt lgkmcnt(0)
    v_lshlrev_b32 v188, 16, v62
    v_and_b32 v189, 0xffff0000, v62
    v_lshlrev_b32 v190, 16, v63
    v_and_b32 v191, 0xffff0000, v63
    v_lshlrev_b32 v192, 16, v64
    v_and_b32 v193, 0xffff0000, v64
    v_lshlrev_b32 v194, 16, v65
    v_and_b32 v195, 0xffff0000, v65
    v_lshlrev_b32 v196, 16, v66
    v_and_b32 v197, 0xffff0000, v66
    v_lshlrev_b32 v198, 16, v67
    v_and_b32 v199, 0xffff0000, v67
    v_lshlrev_b32 v200, 16, v68
    v_and_b32 v201, 0xffff0000, v68
    v_lshlrev_b32 v202, 16, v69
    v_and_b32 v203, 0xffff0000, v69
    v_xor_b32 v70, 0x80008000, v70
    v_lshlrev_b32 v204, 16, v70
    v_and_b32 v205, 0xffff0000, v70
    v_xor_b32 v71, 0x80008000, v71
    v_lshlrev_b32 v206, 16, v71
    v_and_b32 v207, 0xffff0000, v71
    v_xor_b32 v72, 0x80008000, v72
    v_lshlrev_b32 v208, 16, v72
    v_and_b32 v209, 0xffff0000, v72
    v_xor_b32 v73, 0x80008000, v73
    v_lshlrev_b32 v210, 16, v73
    v_and_b32 v211, 0xffff0000, v73
    v_xor_b32 v74, 0x80008000, v74
    v_lshlrev_b32 v212, 16, v74
    v_and_b32 v213, 0xffff0000, v74
    v_xor_b32 v75, 0x80008000, v75
    v_lshlrev_b32 v214, 16, v75
    v_and_b32 v215, 0xffff0000, v75
    v_xor_b32 v76, 0x80008000, v76
    v_lshlrev_b32 v216, 16, v76
    v_and_b32 v217, 0xffff0000, v76
    v_xor_b32 v77, 0x80008000, v77
    v_lshlrev_b32 v218, 16, v77
    v_and_b32 v219, 0xffff0000, v77
    v_and_b32 v224, 1, v3
    v_cmp_eq_u32 vcc, 1, v224
    v_lshrrev_b32 v220, 1, v3
    v_lshl_or_b32 v220, v224, 1, v220
    v_add_u32 v223, 0, v2
    v_sub_u32 v222, 32, v223
    v_cndmask_b32 v223, v223, v222, vcc
    v_bfe_u32 v222, v223, 3, 1
    v_xor_b32 v222, v222, v220
    v_lshlrev_b32 v222, 4, v222
    v_lshl_add_u32 v150, v223, 6, v222
    v_bfe_u32 v222, v223, 1, 2
    v_xor_b32 v222, s3, v222
    v_lshl_add_u32 v150, v222, 2, v150
    v_add_u32 v150, 114688, v150
    v_add_u32 v223, 16, v2
    v_sub_u32 v222, 32, v223
    v_cndmask_b32 v223, v223, v222, vcc
    v_bfe_u32 v222, v223, 3, 1
    v_xor_b32 v222, v222, v220
    v_lshlrev_b32 v222, 4, v222
    v_lshl_add_u32 v151, v223, 6, v222
    v_bfe_u32 v222, v223, 1, 2
    v_xor_b32 v222, s3, v222
    v_lshl_add_u32 v151, v222, 2, v151
    v_add_u32 v151, 114688, v151
    s_lshl_b32 s27, s3, 1
    v_and_b32 v223, 7, v2
    v_xor_b32 v223, s27, v223
    v_lshlrev_b32 v223, 4, v223
    v_lshl_add_u32 v223, v3, 7, v223
    v_lshl_add_u32 v225, v2, 9, v223
    v_add_u32 v225, 114688, v225
    v_lshrrev_b32 v223, 5, v1
    v_and_b32 v224, 7, v1
    v_xor_b32 v224, v224, v223
    v_lshlrev_b32 v152, 4, v224
    v_bfe_u32 v224, v1, 3, 2
    v_lshl_add_u32 v152, v224, 8, v152
    v_lshl_add_u32 v152, v223, 10, v152
    v_xor_b32 v153, 32, v152
    v_xor_b32 v154, 64, v152
    v_xor_b32 v155, 96, v152
    s_lshl_b32 s28, s20, 4
    s_lshr_b32 s29, s21, 1
    s_add_u32 s28, s28, s29
    s_lshl_b32 s28, s28, 15
    s_and_b32 s29, s21, 1
    s_lshl_b32 s29, s29, 7
    s_add_u32 s28, s28, s29
    s_lshl_b32 s29, s3, 13
    s_add_u32 s28, s28, s29
    s_add_u32 s29, s28, 4096
    v_and_b32 v228, 63, v0
    s_cmp_lt_u32 s3, 2
    s_cselect_b32 s44, s6, s8
    s_cselect_b32 s45, s7, s9
    s_mov_b32 s46, 7340032
    s_mov_b32 s47, 0x20000
    v_accvgpr_read_b32 v232, a16
    v_accvgpr_read_b32 v233, a17
    v_accvgpr_read_b32 v234, a18
    v_accvgpr_read_b32 v235, a19
    v_accvgpr_read_b32 v236, a20
    v_accvgpr_read_b32 v237, a21
    v_accvgpr_read_b32 v238, a22
    s_lshr_b32 s40, s2, 3
    s_lshl_b32 s40, s40, 1
    s_and_b32 s41, s3, 1
    s_add_u32 s40, s40, s41
    s_mul_i32 s40, s40, 14336
    s_and_b32 s41, s2, 7
    s_mul_i32 s41, s41, 896
    s_add_u32 s40, s40, s41
    v_and_b32 v239, 7, v228
    v_min_u32 v240, 6, v239
    v_bfe_u32 v239, v228, 3, 1
    v_mul_u32_u24 v239, 7168, v239
    v_lshl_add_u32 v239, v240, 7, v239
    v_add_u32 v242, s40, v239
    s_add_u32 s52, s50, 28672
    s_mov_b32 m0, s52
    s_nop 0
    buffer_load_dwordx4 v232, s[44:47], s51 offen offset:0  lds
    buffer_load_dwordx4 v233, s[44:47], s51 offen offset:1024  lds
    buffer_load_dwordx4 v234, s[44:47], s51 offen offset:2048  lds
    buffer_load_dwordx4 v235, s[44:47], s51 offen offset:3072  lds
    s_add_u32 s52, s52, 4096
    s_mov_b32 m0, s52
    s_nop 0
    buffer_load_dwordx4 v236, s[44:47], s51 offen offset:0  lds
    buffer_load_dwordx4 v237, s[44:47], s51 offen offset:1024  lds
    buffer_load_dwordx4 v238, s[44:47], s51 offen offset:2048  lds
    s_add_u32 s51, s51, 458752
    s_cmp_lg_u32 s3, 0
    s_cbranch_scc1 sequential_preLN__spectral_gfnet__glu_gated_bilinear__prompt_kernel_s2_skip2
    s_waitcnt vmcnt(7)
    v_readfirstlane_b32 s63, v158
    s_sub_u32 s63, 13, s63
    s_cbranch_scc1 sequential_preLN__spectral_gfnet__glu_gated_bilinear__prompt_kernel_s2_nb
sequential_preLN__spectral_gfnet__glu_gated_bilinear__prompt_kernel_s2_bo:
    s_sleep 2
    s_sub_u32 s63, s63, 1
    s_cbranch_scc0 sequential_preLN__spectral_gfnet__glu_gated_bilinear__prompt_kernel_s2_bo
sequential_preLN__spectral_gfnet__glu_gated_bilinear__prompt_kernel_s2_nb:
    s_mov_b32 s63, 16
    s_lshl_b32 s63, s63, 8
    s_add_u32 s63, s63, 41943040
    v_mbcnt_lo_u32_b32 v156, -1, 0
    v_lshl_add_u32 v156, v156, 8, s63
    s_mov_b32 s63, 0x40000
    s_mov_b64 exec, 65535
sequential_preLN__spectral_gfnet__glu_gated_bilinear__prompt_kernel_s2_poll:
    global_load_dword v157, v156, s[10:11] sc1
    s_waitcnt vmcnt(0)
    v_cmp_ne_u32 vcc, 16, v157
    s_sub_u32 s63, s63, 1
    s_cbranch_scc1 sequential_preLN__spectral_gfnet__glu_gated_bilinear__prompt_kernel_s2_done
    s_cbranch_vccz sequential_preLN__spectral_gfnet__glu_gated_bilinear__prompt_kernel_s2_done
    s_sleep 2
    s_branch sequential_preLN__spectral_gfnet__glu_gated_bilinear__prompt_kernel_s2_poll
sequential_preLN__spectral_gfnet__glu_gated_bilinear__prompt_kernel_s2_done:
    s_mov_b64 exec, -1
sequential_preLN__spectral_gfnet__glu_gated_bilinear__prompt_kernel_s2_skip2:
    s_barrier
    s_mov_b32 m0, s23
    s_nop 0
    buffer_load_dwordx4 v60, s[12:15], s24 offen offset:0 sc1 lds
    buffer_load_dwordx4 v60, s[12:15], s24 offen offset:1024 sc1 lds
    buffer_load_dwordx4 v60, s[12:15], s24 offen offset:2048 sc1 lds
    buffer_load_dwordx4 v60, s[12:15], s24 offen offset:3072 sc1 lds
    s_mov_b32 m0, 131072
    s_mov_b64 exec, 15
    buffer_load_dwordx4 v60, s[12:15], s25 offen sc1 lds
    s_mov_b64 exec, -1
    s_mov_b32 s36, 917504
    buffer_load_dword v243, v242, s[44:47], s36 offen
    s_add_u32 s12, s10, 15728640
    s_addc_u32 s13, s11, 0
    s_mov_b32 s14, 16384
    s_mov_b32 s15, 0x20000
    v_add_u32 v60, s23, v60
    s_waitcnt vmcnt(1)
    s_barrier
    ds_read_b32 v78, v150 offset:0
    ds_read_b32 v79, v150 offset:2048
    ds_read_b32 v80, v150 offset:4096
    ds_read_b32 v81, v150 offset:6144
    ds_read_b32 v82, v150 offset:8192
    ds_read_b32 v83, v150 offset:10240
    ds_read_b32 v84, v150 offset:12288
    ds_read_b32 v85, v150 offset:14336
    ds_read_b32 v86, v151 offset:0
    ds_read_b32 v87, v151 offset:2048
    ds_read_b32 v88, v151 offset:4096
    ds_read_b32 v89, v151 offset:6144
    ds_read_b32 v90, v151 offset:8192
    ds_read_b32 v91, v151 offset:10240
    ds_read_b32 v92, v151 offset:12288
    ds_read_b32 v93, v151 offset:14336
    s_waitcnt lgkmcnt(12)
    v_mfma_f32_16x16x32_bf16 v[156:159], v[78:81], v[118:121], 0
    v_mfma_f32_16x16x32_bf16 v[160:163], v[78:81], v[122:125], 0
    s_waitcnt lgkmcnt(8)
    v_mfma_f32_16x16x32_bf16 v[156:159], v[82:85], v[126:129], v[156:159]
    v_mfma_f32_16x16x32_bf16 v[160:163], v[82:85], v[130:133], v[160:163]
    s_waitcnt lgkmcnt(4)
    v_mfma_f32_16x16x32_bf16 v[172:175], v[86:89], v[118:121], 0
    v_mfma_f32_16x16x32_bf16 v[176:179], v[86:89], v[122:125], 0
    s_waitcnt lgkmcnt(0)
    v_mfma_f32_16x16x32_bf16 v[172:175], v[90:93], v[126:129], v[172:175]
    v_mfma_f32_16x16x32_bf16 v[176:179], v[90:93], v[130:133], v[176:179]
    v_mfma_f32_16x16x32_bf16 v[164:167], v[78:81], v[134:137], 0
    v_mul_f32 v94, v156, v44
    v_mul_f32 v95, v157, v45
    v_mfma_f32_16x16x32_bf16 v[168:171], v[78:81], v[138:141], 0
    v_mul_f32 v96, v158, v46
    v_mul_f32 v97, v159, v47
    v_mfma_f32_16x16x32_bf16 v[164:167], v[82:85], v[142:145], v[164:167]
    v_mul_f32 v156, v156, v28
    v_mul_f32 v157, v157, v29
    v_mfma_f32_16x16x32_bf16 v[168:171], v[82:85], v[146:149], v[168:171]
    v_mul_f32 v158, v158, v30
    v_mul_f32 v159, v159, v31
    v_mfma_f32_16x16x32_bf16 v[180:183], v[86:89], v[134:137], 0
    v_fmac_f32 v156, v160, v44
    v_fmac_f32 v157, v161, v45
    v_mfma_f32_16x16x32_bf16 v[184:187], v[86:89], v[138:141], 0
    v_fmac_f32 v158, v162, v46
    v_fmac_f32 v159, v163, v47
    v_mfma_f32_16x16x32_bf16 v[180:183], v[90:93], v[142:145], v[180:183]
    v_fma_f32 v160, v160, v28, -v94
    v_fma_f32 v161, v161, v29, -v95
    v_mfma_f32_16x16x32_bf16 v[184:187], v[90:93], v[146:149], v[184:187]
    v_fma_f32 v162, v162, v30, -v96
    v_fma_f32 v163, v163, v31, -v97
    v_pk_mul_f32 v[94:95], v[172:173], v[48:49]
    v_pk_mul_f32 v[96:97], v[174:175], v[50:51]
    v_pk_mul_f32 v[172:173], v[172:173], v[32:33]
    v_pk_mul_f32 v[174:175], v[174:175], v[34:35]
    v_pk_fma_f32 v[172:173], v[176:177], v[48:49], v[172:173]
    v_pk_fma_f32 v[174:175], v[178:179], v[50:51], v[174:175]
    v_pk_fma_f32 v[176:177], v[176:177], v[32:33], v[94:95] neg_lo:[0,0,1] neg_hi:[0,0,1]
    v_pk_fma_f32 v[178:179], v[178:179], v[34:35], v[96:97] neg_lo:[0,0,1] neg_hi:[0,0,1]
    v_cvt_pk_bf16_f32 v78, v156, v157
    v_cvt_pk_bf16_f32 v79, v158, v159
    v_cvt_pk_bf16_f32 v80, v160, v161
    v_cvt_pk_bf16_f32 v81, v162, v163
    v_cvt_pk_bf16_f32 v82, v172, v173
    v_cvt_pk_bf16_f32 v83, v174, v175
    v_cvt_pk_bf16_f32 v84, v176, v177
    v_cvt_pk_bf16_f32 v85, v178, v179
    v_mfma_f32_16x16x32_bf16 v[188:191], v[78:81], v[6:9], v[188:191]
    v_mul_f32 v94, v164, v52
    v_mul_f32 v95, v165, v53
    v_mfma_f32_16x16x32_bf16 v[204:207], v[78:81], v[4:7], v[204:207]
    v_mul_f32 v96, v166, v54
    v_mul_f32 v97, v167, v55
    v_mfma_f32_16x16x32_bf16 v[196:199], v[78:81], v[18:21], v[196:199]
    v_mul_f32 v164, v164, v36
    v_mul_f32 v165, v165, v37
    v_mfma_f32_16x16x32_bf16 v[212:215], v[78:81], v[16:19], v[212:215]
    v_mul_f32 v166, v166, v38
    v_mul_f32 v167, v167, v39
    v_mfma_f32_16x16x32_bf16 v[188:191], v[82:85], v[12:15], v[188:191]
    v_fmac_f32 v164, v168, v52
    v_fmac_f32 v165, v169, v53
    v_mfma_f32_16x16x32_bf16 v[204:207], v[82:85], v[10:13], v[204:207]
    v_fmac_f32 v166, v170, v54
    v_fmac_f32 v167, v171, v55
    v_mfma_f32_16x16x32_bf16 v[196:199], v[82:85], v[24:27], v[196:199]
    v_fma_f32 v168, v168, v36, -v94
    v_fma_f32 v169, v169, v37, -v95
    v_mfma_f32_16x16x32_bf16 v[212:215], v[82:85], v[22:25], v[212:215]
    v_fma_f32 v170, v170, v38, -v96
    v_fma_f32 v171, v171, v39, -v97
    v_pk_mul_f32 v[94:95], v[180:181], v[56:57]
    v_pk_mul_f32 v[96:97], v[182:183], v[58:59]
    v_pk_mul_f32 v[180:181], v[180:181], v[40:41]
    v_pk_mul_f32 v[182:183], v[182:183], v[42:43]
    v_pk_fma_f32 v[180:181], v[184:185], v[56:57], v[180:181]
    v_pk_fma_f32 v[182:183], v[186:187], v[58:59], v[182:183]
    v_pk_fma_f32 v[184:185], v[184:185], v[40:41], v[94:95] neg_lo:[0,0,1] neg_hi:[0,0,1]
    v_pk_fma_f32 v[186:187], v[186:187], v[42:43], v[96:97] neg_lo:[0,0,1] neg_hi:[0,0,1]
    v_cvt_pk_bf16_f32 v86, v164, v165
    v_cvt_pk_bf16_f32 v87, v166, v167
    v_cvt_pk_bf16_f32 v88, v168, v169
    v_cvt_pk_bf16_f32 v89, v170, v171
    v_cvt_pk_bf16_f32 v90, v180, v181
    v_cvt_pk_bf16_f32 v91, v182, v183
    v_cvt_pk_bf16_f32 v92, v184, v185
    v_cvt_pk_bf16_f32 v93, v186, v187
    v_mfma_f32_16x16x32_bf16 v[192:195], v[86:89], v[6:9], v[192:195]
    v_mfma_f32_16x16x32_bf16 v[208:211], v[86:89], v[4:7], v[208:211]
    v_mfma_f32_16x16x32_bf16 v[200:203], v[86:89], v[18:21], v[200:203]
    v_mfma_f32_16x16x32_bf16 v[216:219], v[86:89], v[16:19], v[216:219]
    v_mfma_f32_16x16x32_bf16 v[192:195], v[90:93], v[12:15], v[192:195]
    v_mfma_f32_16x16x32_bf16 v[208:211], v[90:93], v[10:13], v[208:211]
    v_mfma_f32_16x16x32_bf16 v[200:203], v[90:93], v[24:27], v[200:203]
    v_mfma_f32_16x16x32_bf16 v[216:219], v[90:93], v[22:25], v[216:219]
    v_pk_mul_f32 v[104:105], v[188:189], v[188:189]
    v_pk_add_f32 v[102:103], v[190:191], v[188:189]
    v_pk_fma_f32 v[104:105], v[190:191], v[190:191], v[104:105]
    s_nop 1
    v_pk_add_f32 v[102:103], v[192:193], v[102:103]
    v_pk_fma_f32 v[104:105], v[192:193], v[192:193], v[104:105]
    v_pk_add_f32 v[102:103], v[194:195], v[102:103]
    v_pk_fma_f32 v[104:105], v[194:195], v[194:195], v[104:105]
    v_pk_add_f32 v[102:103], v[196:197], v[102:103]
    v_pk_fma_f32 v[104:105], v[196:197], v[196:197], v[104:105]
    v_pk_add_f32 v[102:103], v[198:199], v[102:103]
    v_pk_fma_f32 v[104:105], v[198:199], v[198:199], v[104:105]
    v_pk_add_f32 v[102:103], v[200:201], v[102:103]
    v_pk_fma_f32 v[104:105], v[200:201], v[200:201], v[104:105]
    v_pk_add_f32 v[102:103], v[202:203], v[102:103]
    v_pk_fma_f32 v[104:105], v[202:203], v[202:203], v[104:105]
    v_pk_mul_f32 v[108:109], v[204:205], v[204:205]
    v_pk_add_f32 v[106:107], v[206:207], v[204:205]
    v_pk_fma_f32 v[108:109], v[206:207], v[206:207], v[108:109]
    v_pk_add_f32 v[106:107], v[208:209], v[106:107]
    v_pk_fma_f32 v[108:109], v[208:209], v[208:209], v[108:109]
    v_pk_add_f32 v[106:107], v[210:211], v[106:107]
    v_pk_fma_f32 v[108:109], v[210:211], v[210:211], v[108:109]
    v_pk_add_f32 v[106:107], v[212:213], v[106:107]
    v_pk_fma_f32 v[108:109], v[212:213], v[212:213], v[108:109]
    v_pk_add_f32 v[106:107], v[214:215], v[106:107]
    v_pk_fma_f32 v[108:109], v[214:215], v[214:215], v[108:109]
    v_pk_add_f32 v[106:107], v[216:217], v[106:107]
    v_pk_fma_f32 v[108:109], v[216:217], v[216:217], v[108:109]
    v_pk_add_f32 v[106:107], v[218:219], v[106:107]
    v_pk_fma_f32 v[108:109], v[218:219], v[218:219], v[108:109]
    v_add_f32 v102, v102, v103
    v_add_f32 v104, v104, v105
    v_add_f32 v106, v106, v107
    v_add_f32 v108, v108, v109
    v_permlane16_swap_b32 v102, v104
    s_nop 0
    v_permlane16_swap_b32 v106, v108
    v_add_f32 v102, v102, v104
    v_add_f32 v106, v106, v108
    s_nop 1
    v_permlane32_swap_b32 v102, v106
    v_add_f32 v102, v102, v106
    s_nop 1
    v_add_f32 v102, v102, v102 row_ror:8
    s_nop 1
    v_add_f32 v102, v102, v102 row_ror:4
    s_nop 1
    v_add_f32 v102, v102, v102 row_ror:2
    s_nop 1
    v_add_f32 v102, v102, v102 row_ror:1
    v_mul_f32 v102, 0x3a800000, v102
    s_nop 0
    v_readlane_b32 s40, v102, 0
    v_readlane_b32 s41, v102, 16
    v_readlane_b32 s42, v102, 32
    v_readlane_b32 s43, v102, 48
    v_mov_b32 v94, s41
    s_nop 0
    v_mov_b32 v95, s43
    v_fma_f32 v94, -s40, s40, v94
    v_fma_f32 v95, -s42, s42, v95
    v_max_f32 v94, 0, v94
    v_max_f32 v95, 0, v95
    v_add_f32 v94, 0x3727c5ac, v94
    v_add_f32 v95, 0x3727c5ac, v95
    v_rsq_f32 v110, v94
    v_rsq_f32 v112, v95
    v_mul_f32 v111, s40, v110
    v_mul_f32 v113, s42, v112
    v_xor_b32 v223, 16, v225
    v_mov_b32 v62, s40
    v_mul_f32 v63, v94, v110
    v_sub_f32 v64, 0, s42
    v_mul_f32 v65, v95, v112
    s_lshl_b32 s27, s3, 4
    s_add_u32 s27, s27, 148480
    v_mov_b32 v224, s27
    ds_write_b128 v224, v[62:65]
    v_pk_fma_f32 v[188:189], v[188:189], v[110:111], v[110:111] op_sel:[0,0,1] op_sel_hi:[1,0,1] neg_lo:[0,0,1] neg_hi:[0,0,1]
    v_pk_fma_f32 v[190:191], v[190:191], v[110:111], v[110:111] op_sel:[0,0,1] op_sel_hi:[1,0,1] neg_lo:[0,0,1] neg_hi:[0,0,1]
    v_pk_fma_f32 v[192:193], v[192:193], v[110:111], v[110:111] op_sel:[0,0,1] op_sel_hi:[1,0,1] neg_lo:[0,0,1] neg_hi:[0,0,1]
    v_pk_fma_f32 v[194:195], v[194:195], v[110:111], v[110:111] op_sel:[0,0,1] op_sel_hi:[1,0,1] neg_lo:[0,0,1] neg_hi:[0,0,1]
    v_cvt_pk_bf16_f32 v78, v188, v189
    v_cvt_pk_bf16_f32 v79, v190, v191
    v_cvt_pk_bf16_f32 v80, v192, v193
    v_cvt_pk_bf16_f32 v81, v194, v195
    ds_write_b128 v225, v[78:81] offset:17408
    v_pk_fma_f32 v[196:197], v[196:197], v[110:111], v[110:111] op_sel:[0,0,1] op_sel_hi:[1,0,1] neg_lo:[0,0,1] neg_hi:[0,0,1]
    v_pk_fma_f32 v[198:199], v[198:199], v[110:111], v[110:111] op_sel:[0,0,1] op_sel_hi:[1,0,1] neg_lo:[0,0,1] neg_hi:[0,0,1]
    v_pk_fma_f32 v[200:201], v[200:201], v[110:111], v[110:111] op_sel:[0,0,1] op_sel_hi:[1,0,1] neg_lo:[0,0,1] neg_hi:[0,0,1]
    v_pk_fma_f32 v[202:203], v[202:203], v[110:111], v[110:111] op_sel:[0,0,1] op_sel_hi:[1,0,1] neg_lo:[0,0,1] neg_hi:[0,0,1]
    v_cvt_pk_bf16_f32 v82, v196, v197
    v_cvt_pk_bf16_f32 v83, v198, v199
    v_cvt_pk_bf16_f32 v84, v200, v201
    v_cvt_pk_bf16_f32 v85, v202, v203
    ds_write_b128 v225, v[82:85] offset:25600
    v_pk_fma_f32 v[204:205], v[204:205], v[112:113], v[112:113] op_sel:[0,0,1] op_sel_hi:[1,0,1] neg_lo:[0,0,1] neg_hi:[0,0,1]
    v_pk_fma_f32 v[206:207], v[206:207], v[112:113], v[112:113] op_sel:[0,0,1] op_sel_hi:[1,0,1] neg_lo:[0,0,1] neg_hi:[0,0,1]
    v_pk_fma_f32 v[208:209], v[208:209], v[112:113], v[112:113] op_sel:[0,0,1] op_sel_hi:[1,0,1] neg_lo:[0,0,1] neg_hi:[0,0,1]
    v_pk_fma_f32 v[210:211], v[210:211], v[112:113], v[112:113] op_sel:[0,0,1] op_sel_hi:[1,0,1] neg_lo:[0,0,1] neg_hi:[0,0,1]
    v_cvt_pk_bf16_f32 v86, -v204, -v205
    v_cvt_pk_bf16_f32 v87, -v206, -v207
    v_cvt_pk_bf16_f32 v88, -v208, -v209
    v_cvt_pk_bf16_f32 v89, -v210, -v211
    ds_write_b128 v223, v[86:89] offset:17408
    v_pk_fma_f32 v[212:213], v[212:213], v[112:113], v[112:113] op_sel:[0,0,1] op_sel_hi:[1,0,1] neg_lo:[0,0,1] neg_hi:[0,0,1]
    v_pk_fma_f32 v[214:215], v[214:215], v[112:113], v[112:113] op_sel:[0,0,1] op_sel_hi:[1,0,1] neg_lo:[0,0,1] neg_hi:[0,0,1]
    v_pk_fma_f32 v[216:217], v[216:217], v[112:113], v[112:113] op_sel:[0,0,1] op_sel_hi:[1,0,1] neg_lo:[0,0,1] neg_hi:[0,0,1]
    v_pk_fma_f32 v[218:219], v[218:219], v[112:113], v[112:113] op_sel:[0,0,1] op_sel_hi:[1,0,1] neg_lo:[0,0,1] neg_hi:[0,0,1]
    v_cvt_pk_bf16_f32 v90, -v212, -v213
    v_cvt_pk_bf16_f32 v91, -v214, -v215
    v_cvt_pk_bf16_f32 v92, -v216, -v217
    v_cvt_pk_bf16_f32 v93, -v218, -v219
    ds_write_b128 v223, v[90:93] offset:25600
    v_and_b32 v224, 3, v1
    v_lshlrev_b32 v224, 4, v224
    v_add_u32 v222, 114688, v224
    s_lshl_b32 s27, s20, 5
    s_add_u32 s27, s27, s21
    s_lshl_b32 s27, s27, 6
    s_waitcnt lgkmcnt(0)
    s_barrier
    ds_read_b128 v[156:159], v60 offset:17408
    ds_read_b128 v[160:163], v60 offset:18432
    ds_read_b128 v[164:167], v60 offset:19456
    ds_read_b128 v[168:171], v60 offset:20480
    ds_read_b128 v[62:65], v222 offset:33792
    s_waitcnt lgkmcnt(4)
    buffer_store_dwordx4 v[156:159], v152, s[16:19], s28 offen offset:0 sc1
    s_waitcnt lgkmcnt(3)
    buffer_store_dwordx4 v[160:163], v153, s[16:19], s28 offen offset:2048 sc1
    s_waitcnt lgkmcnt(2)
    buffer_store_dwordx4 v[164:167], v154, s[16:19], s29 offen offset:0 sc1
    s_waitcnt lgkmcnt(1)
    buffer_store_dwordx4 v[168:171], v155, s[16:19], s29 offen offset:2048 sc1
    s_cmp_lg_u32 s3, 0
    s_cbranch_scc1 sequential_preLN__spectral_gfnet__glu_gated_bilinear__prompt_kernel_p3_ns
    s_waitcnt lgkmcnt(0)
    s_mov_b64 exec, 15
    buffer_store_dwordx4 v[62:65], v224, s[12:15], s27 offen sc1
    s_mov_b64 exec, -1
sequential_preLN__spectral_gfnet__glu_gated_bilinear__prompt_kernel_p3_ns:
    s_waitcnt lgkmcnt(0)
    v_lshlrev_b32 v231, 4, v228
    s_lshl_b32 s28, s49, 4
    s_lshl_b32 s29, s3, 2
    s_add_u32 s28, s28, s29
    s_lshl_b32 s32, s28, 15
    s_add_u32 s33, s32, 0x8000
    s_add_u32 s34, s32, 0x10000
    s_add_u32 s35, s32, 0x18000
    s_add_u32 s16, s10, 20971520
    s_addc_u32 s17, s11, 0
    s_mov_b32 s18, 4194304
    s_mov_b32 s19, 0x20000
    s_and_b32 s22, s2, 7
    v_and_b32 v239, 7, v228
    s_lshl_b32 s24, s2, 2
    s_add_u32 s24, s24, s3
    s_lshl_b32 s24, s24, 3
    v_add_lshl_u32 v244, v239, s24, 7
    s_mov_b32 s20, s56
    s_mov_b32 s21, s57
    s_mov_b32 s22, 7340032
    s_mov_b32 s23, 0x20000
    s_mov_b32 s24, 0
    s_mov_b32 s38, 1835008
    v_lshrrev_b32 v239, 2, v228
    v_mul_u32_u24 v239, 224, v239
    v_and_b32 v240, 3, v228
    v_lshl_add_u32 v239, v240, 3, v239
    s_and_b32 s36, s48, 1
    s_lshl_b32 s37, s36, 5
    v_add_u32 v229, s37, v239
    s_cmp_eq_u32 s36, 0
    s_cselect_b32 s37, 192, 0
    v_add_u32 v230, s37, v239
    v_bfe_u32 v239, v228, 4, 1
    v_lshrrev_b32 v240, 5, v228
    v_and_b32 v241, 15, v228
    v_lshlrev_b32 v241, 4, v241
    v_lshl_add_u32 v241, v240, 8, v241
    v_lshl_add_u32 v250, v239, 9, v241
    v_mul_u32_u24 v239, 114688, v239
    v_add_u32 v251, v239, v241
    s_lshr_b32 s37, s48, 1
    s_mul_i32 s37, s37, 7
    s_add_u32 s41, s37, 3
    s_lshl_b32 s42, s36, 2
    s_add_u32 s37, s37, s42
    s_lshl_b32 s37, s37, 10
    s_lshl_b32 s41, s41, 10
    s_lshl_b32 s42, s36, 9
    s_add_u32 s41, s41, s42
    s_mul_i32 s28, s28, 114688
    s_add_u32 s37, s37, s28
    s_add_u32 s41, s41, s28
    s_add_u32 s42, s41, 229376
    s_add_u32 s28, s37, 114688
    s_add_u32 s29, s37, 229376
    s_add_u32 s30, s37, 344064
    s_and_b32 s25, s2, 3
    s_lshl_b32 s25, s25, 2
    s_lshr_b32 s60, s2, 6
    s_add_u32 s25, s25, s60
    s_bfe_u32 s26, s2, 0x10002
    s_bfe_u32 s61, s2, 0x30003
    s_lshl_b32 s63, s61, 8
    s_lshl_b32 s27, s26, 7
    s_add_u32 s27, s27, s63
    s_add_u32 s60, s60, s61
    s_and_b32 s60, s60, 3
    s_lshl_b32 s61, s3, 12
    v_lshrrev_b32 v239, 4, v228
    v_lshlrev_b32 v240, 1, v239
    v_and_b32 v241, 15, v228
    v_xor_b32 v241, v241, v240
    v_lshlrev_b32 v241, 4, v241
    v_lshl_add_u32 v241, v239, 11, v241
    s_mul_i32 s54, s26, 3670016
    s_add_u32 s63, s63, s54
    s_lshl_b32 s54, s3, 15
    s_add_u32 s63, s63, s54
    v_add_u32 v246, s63, v241
    v_add_u32 v247, 7168, v246
    v_xor_b32 v241, 128, v246
    v_add_u32 v248, 14336, v241
    v_add_u32 v249, 21504, v241
    s_mov_b32 s12, s56
    s_mov_b32 s13, s57
    s_mov_b32 s14, 7340032
    s_mov_b32 s15, 0x20000
    v_mov_b32 v0, 0
    v_mov_b32 v1, 0
    v_mov_b32 v2, 0
    v_mov_b32 v3, 0
    v_mov_b32 v4, 0
    v_mov_b32 v5, 0
    v_mov_b32 v6, 0
    v_mov_b32 v7, 0
    v_mov_b32 v8, 0
    v_mov_b32 v9, 0
    v_mov_b32 v10, 0
    v_mov_b32 v11, 0
    v_mov_b32 v12, 0
    v_mov_b32 v13, 0
    v_mov_b32 v14, 0
    v_mov_b32 v15, 0
    v_mov_b32 v16, 0
    v_mov_b32 v17, 0
    v_mov_b32 v18, 0
    v_mov_b32 v19, 0
    v_mov_b32 v20, 0
    v_mov_b32 v21, 0
    v_mov_b32 v22, 0
    v_mov_b32 v23, 0
    v_mov_b32 v24, 0
    v_mov_b32 v25, 0
    v_mov_b32 v26, 0
    v_mov_b32 v27, 0
    v_mov_b32 v28, 0
    v_mov_b32 v29, 0
    v_mov_b32 v30, 0
    v_mov_b32 v31, 0
    v_mov_b32 v32, 0
    v_mov_b32 v33, 0
    v_mov_b32 v34, 0
    v_mov_b32 v35, 0
    v_mov_b32 v36, 0
    v_mov_b32 v37, 0
    v_mov_b32 v38, 0
    v_mov_b32 v39, 0
    v_mov_b32 v40, 0
    v_mov_b32 v41, 0
    v_mov_b32 v42, 0
    v_mov_b32 v43, 0
    v_mov_b32 v44, 0
    v_mov_b32 v45, 0
    v_mov_b32 v46, 0
    v_mov_b32 v47, 0
    v_mov_b32 v48, 0
    v_mov_b32 v49, 0
    v_mov_b32 v50, 0
    v_mov_b32 v51, 0
    v_mov_b32 v52, 0
    v_mov_b32 v53, 0
    v_mov_b32 v54, 0
    v_mov_b32 v55, 0
    v_mov_b32 v56, 0
    v_mov_b32 v57, 0
    v_mov_b32 v58, 0
    v_mov_b32 v59, 0
    v_mov_b32 v60, 0
    v_mov_b32 v61, 0
    v_mov_b32 v62, 0
    v_mov_b32 v63, 0
    v_mov_b32 v64, 0
    v_mov_b32 v65, 0
    v_mov_b32 v66, 0
    v_mov_b32 v67, 0
    v_mov_b32 v68, 0
    v_mov_b32 v69, 0
    v_mov_b32 v70, 0
    v_mov_b32 v71, 0
    v_mov_b32 v72, 0
    v_mov_b32 v73, 0
    v_mov_b32 v74, 0
    v_mov_b32 v75, 0
    v_mov_b32 v76, 0
    v_mov_b32 v77, 0
    v_mov_b32 v78, 0
    v_mov_b32 v79, 0
    v_mov_b32 v80, 0
    v_mov_b32 v81, 0
    v_mov_b32 v82, 0
    v_mov_b32 v83, 0
    v_mov_b32 v84, 0
    v_mov_b32 v85, 0
    v_mov_b32 v86, 0
    v_mov_b32 v87, 0
    v_mov_b32 v88, 0
    v_mov_b32 v89, 0
    v_mov_b32 v90, 0
    v_mov_b32 v91, 0
    v_mov_b32 v92, 0
    v_mov_b32 v93, 0
    v_mov_b32 v94, 0
    v_mov_b32 v95, 0
    v_mov_b32 v96, 0
    v_mov_b32 v97, 0
    v_mov_b32 v98, 0
    v_mov_b32 v99, 0
    v_mov_b32 v100, 0
    v_mov_b32 v101, 0
    v_mov_b32 v102, 0
    v_mov_b32 v103, 0
    v_mov_b32 v104, 0
    v_mov_b32 v105, 0
    v_mov_b32 v106, 0
    v_mov_b32 v107, 0
    v_mov_b32 v108, 0
    v_mov_b32 v109, 0
    v_mov_b32 v110, 0
    s_waitcnt vmcnt(0)
    s_barrier
    s_cmp_lg_u32 s3, 0
    s_cbranch_scc1 sequential_preLN__spectral_gfnet__glu_gated_bilinear__prompt_kernel_a_skip1
    s_and_b32 s63, s2, 7
    s_add_u32 s63, s63, 32
    s_lshl_b32 s63, s63, 8
    s_add_u32 s63, s63, 41943040
    v_mov_b32 v224, s63
    v_mov_b32 v225, 1
    s_mov_b64 exec, 1
    s_and_b32 s63, s2, 7
    s_lshl_b32 s63, s63, 5
    s_lshr_b32 vcc_lo, s2, 3
    s_add_u32 s63, s63, vcc_lo
    s_lshl_b32 s63, s63, 7
    s_add_u32 s63, s63, 42074112
    v_mov_b32 v227, s63
    global_store_dword v227, v225, s[10:11] sc1
    global_atomic_add v226, v224, v225, s[10:11] sc0 sc1
    s_mov_b64 exec, -1
sequential_preLN__spectral_gfnet__glu_gated_bilinear__prompt_kernel_a_skip1:
    v_mov_b32 v111, 0
    v_mov_b32 v112, 0
    v_mov_b32 v113, 0
    v_mov_b32 v114, 0
    v_mov_b32 v115, 0
    v_mov_b32 v116, 0
    v_mov_b32 v117, 0
    v_mov_b32 v118, 0
    v_mov_b32 v119, 0
    v_mov_b32 v120, 0
    v_mov_b32 v121, 0
    v_mov_b32 v122, 0
    v_mov_b32 v123, 0
    v_mov_b32 v124, 0
    v_mov_b32 v125, 0
    v_mov_b32 v126, 0
    v_mov_b32 v127, 0
    v_mov_b32 v128, 0
    v_mov_b32 v129, 0
    v_mov_b32 v130, 0
    v_mov_b32 v131, 0
    v_mov_b32 v132, 0
    v_mov_b32 v133, 0
    v_mov_b32 v134, 0
    v_mov_b32 v135, 0
    v_mov_b32 v136, 0
    v_mov_b32 v137, 0
    v_mov_b32 v138, 0
    v_mov_b32 v139, 0
    v_mov_b32 v140, 0
    v_mov_b32 v141, 0
    v_mov_b32 v142, 0
    v_mov_b32 v143, 0
    v_mov_b32 v144, 0
    v_mov_b32 v145, 0
    v_mov_b32 v146, 0
    v_mov_b32 v147, 0
    v_mov_b32 v148, 0
    v_mov_b32 v149, 0
    v_mov_b32 v150, 0
    v_mov_b32 v151, 0
    v_mov_b32 v152, 0
    v_mov_b32 v153, 0
    v_mov_b32 v154, 0
    v_mov_b32 v155, 0
    v_mov_b32 v156, 0
    v_mov_b32 v157, 0
    v_mov_b32 v158, 0
    v_mov_b32 v159, 0
    v_mov_b32 v160, 0
    v_mov_b32 v161, 0
    v_mov_b32 v162, 0
    v_mov_b32 v163, 0
    v_mov_b32 v164, 0
    v_mov_b32 v165, 0
    v_mov_b32 v166, 0
    v_mov_b32 v167, 0
    v_mov_b32 v168, 0
    v_mov_b32 v169, 0
    v_mov_b32 v170, 0
    v_mov_b32 v171, 0
    v_mov_b32 v172, 0
    v_mov_b32 v173, 0
    v_mov_b32 v174, 0
    v_mov_b32 v175, 0
    v_mov_b32 v176, 0
    v_mov_b32 v177, 0
    v_mov_b32 v178, 0
    v_mov_b32 v179, 0
    v_mov_b32 v180, 0
    v_mov_b32 v181, 0
    v_mov_b32 v182, 0
    v_mov_b32 v183, 0
    v_mov_b32 v184, 0
    v_mov_b32 v185, 0
    v_mov_b32 v186, 0
    v_mov_b32 v187, 0
    v_mov_b32 v188, 0
    v_mov_b32 v189, 0
    v_mov_b32 v190, 0
    v_mov_b32 v191, 0
    v_mov_b32 v192, 0
    v_mov_b32 v193, 0
    v_mov_b32 v194, 0
    v_mov_b32 v195, 0
    v_mov_b32 v196, 0
    v_mov_b32 v197, 0
    v_mov_b32 v198, 0
    v_mov_b32 v199, 0
    v_mov_b32 v200, 0
    v_mov_b32 v201, 0
    v_mov_b32 v202, 0
    v_mov_b32 v203, 0
    v_mov_b32 v204, 0
    v_mov_b32 v205, 0
    v_mov_b32 v206, 0
    v_mov_b32 v207, 0
    v_mov_b32 v208, 0
    v_mov_b32 v209, 0
    v_mov_b32 v210, 0
    v_mov_b32 v211, 0
    v_mov_b32 v212, 0
    v_mov_b32 v213, 0
    v_mov_b32 v214, 0
    v_mov_b32 v215, 0
    v_mov_b32 v216, 0
    v_mov_b32 v217, 0
    v_mov_b32 v218, 0
    v_mov_b32 v219, 0
    v_mov_b32 v220, 0
    v_mov_b32 v221, 0
    v_mov_b32 v222, 0
    v_mov_b32 v223, 0
    s_cmp_lg_u32 s3, 0
    s_cbranch_scc1 sequential_preLN__spectral_gfnet__glu_gated_bilinear__prompt_kernel_a_skip2
    s_waitcnt vmcnt(0)
    v_readfirstlane_b32 s63, v226
    s_sub_u32 s63, 27, s63
    s_cbranch_scc1 sequential_preLN__spectral_gfnet__glu_gated_bilinear__prompt_kernel_a_nb
sequential_preLN__spectral_gfnet__glu_gated_bilinear__prompt_kernel_a_bo:
    s_sleep 0
    s_sub_u32 s63, s63, 1
    s_cbranch_scc0 sequential_preLN__spectral_gfnet__glu_gated_bilinear__prompt_kernel_a_bo
sequential_preLN__spectral_gfnet__glu_gated_bilinear__prompt_kernel_a_nb:
    s_lshl_b32 s63, s49, 5
    s_lshl_b32 s63, s63, 7
    s_add_u32 s63, s63, 42074112
    v_mbcnt_lo_u32_b32 v224, -1, 0
    v_lshl_add_u32 v224, v224, 7, s63
    s_mov_b32 s63, 0x40000
    s_mov_b32 exec_lo, 4294967295
    s_mov_b32 exec_hi, 0
sequential_preLN__spectral_gfnet__glu_gated_bilinear__prompt_kernel_a_poll:
    global_load_dword v225, v224, s[10:11] sc1
    s_waitcnt vmcnt(0)
    v_cmp_ne_u32 vcc, 1, v225
    s_sub_u32 s63, s63, 1
    s_cbranch_scc1 sequential_preLN__spectral_gfnet__glu_gated_bilinear__prompt_kernel_a_done
    s_cbranch_vccz sequential_preLN__spectral_gfnet__glu_gated_bilinear__prompt_kernel_a_done
    s_sleep 2
    s_branch sequential_preLN__spectral_gfnet__glu_gated_bilinear__prompt_kernel_a_poll
sequential_preLN__spectral_gfnet__glu_gated_bilinear__prompt_kernel_a_done:
    s_mov_b64 exec, -1
sequential_preLN__spectral_gfnet__glu_gated_bilinear__prompt_kernel_a_skip2:
    s_barrier
    buffer_load_dwordx4 a[16:19], v231, s[16:19], s32 offen offset:0 sc1
    buffer_load_dwordx4 a[20:23], v231, s[16:19], s33 offen offset:0 sc1
    buffer_load_dwordx4 a[24:27], v231, s[16:19], s34 offen offset:0 sc1
    buffer_load_dwordx4 a[28:31], v231, s[16:19], s35 offen offset:0 sc1
    buffer_load_dwordx4 a[32:35], v231, s[16:19], s32 offen offset:1024 sc1
    buffer_load_dwordx4 a[36:39], v231, s[16:19], s33 offen offset:1024 sc1
    buffer_load_dwordx4 a[40:43], v231, s[16:19], s34 offen offset:1024 sc1
    buffer_load_dwordx4 a[44:47], v231, s[16:19], s35 offen offset:1024 sc1
    buffer_load_dword v243, v231, s[20:23], s22 offen
    buffer_load_dword v243, v231, s[20:23], s22 offen
    buffer_load_dword v243, v231, s[20:23], s22 offen
    buffer_load_dword v243, v231, s[20:23], s22 offen
    buffer_load_dword v243, v231, s[20:23], s22 offen
    buffer_load_dword v243, v231, s[20:23], s22 offen
    buffer_load_dword v243, v231, s[20:23], s22 offen
    buffer_load_dwordx4 a[48:51], v231, s[16:19], s32 offen offset:2048 sc1
    buffer_load_dwordx4 a[52:55], v231, s[16:19], s33 offen offset:2048 sc1
    buffer_load_dwordx4 a[56:59], v231, s[16:19], s34 offen offset:2048 sc1
    buffer_load_dwordx4 a[60:63], v231, s[16:19], s35 offen offset:2048 sc1
    ds_read_b64_tr_b16 a[0:1], v230 offset:0
    ds_read_b64_tr_b16 a[2:3], v230 offset:3584
    ds_read_b64_tr_b16 a[4:5], v230 offset:14336
    ds_read_b64_tr_b16 a[6:7], v230 offset:17920
    ds_read_b64_tr_b16 a[8:9], v229 offset:0
    ds_read_b64_tr_b16 a[10:11], v229 offset:3584
    s_mov_b32 s39, 0
    s_mov_b32 s40, 0
sequential_preLN__spectral_gfnet__glu_gated_bilinear__prompt_kernel_loop4:
    s_waitcnt vmcnt(15) lgkmcnt(4)
    v_mfma_f32_16x16x32_bf16 v[192:195], a[0:3], a[16:19], v[192:195]
    ds_read_b64_tr_b16 a[12:13], v229 offset:14336
    v_mfma_f32_16x16x32_bf16 v[196:199], a[0:3], a[20:23], v[196:199]
    ds_read_b64_tr_b16 a[14:15], v229 offset:17920
    v_mfma_f32_16x16x32_bf16 v[200:203], a[0:3], a[24:27], v[200:203]
    buffer_load_dwordx4 a[64:67], v231, s[16:19], s32 offen offset:3072 sc1
    s_add_u32 s32, s32, 4096
    v_mfma_f32_16x16x32_bf16 v[204:207], a[0:3], a[28:31], v[204:207]
    s_waitcnt lgkmcnt(4)
    v_mfma_f32_16x16x32_bf16 v[220:223], a[4:7], a[28:31], v[220:223]
    ds_read_b64_tr_b16 a[0:1], v229 offset:32
    v_mfma_f32_16x16x32_bf16 v[216:219], a[4:7], a[24:27], v[216:219]
    ds_read_b64_tr_b16 a[2:3], v229 offset:3616
    v_mfma_f32_16x16x32_bf16 v[212:215], a[4:7], a[20:23], v[212:215]
    buffer_load_dwordx4 a[68:71], v231, s[16:19], s33 offen offset:3072 sc1
    s_add_u32 s33, s33, 4096
    v_mfma_f32_16x16x32_bf16 v[208:211], a[4:7], a[16:19], v[208:211]
    s_waitcnt lgkmcnt(4)
    v_mfma_f32_16x16x32_bf16 v[0:3], a[8:11], a[16:19], v[0:3]
    ds_read_b64_tr_b16 a[4:5], v229 offset:14368
    v_mfma_f32_16x16x32_bf16 v[4:7], a[8:11], a[20:23], v[4:7]
    ds_read_b64_tr_b16 a[6:7], v229 offset:17952
    v_mfma_f32_16x16x32_bf16 v[8:11], a[8:11], a[24:27], v[8:11]
    buffer_load_dwordx4 a[72:75], v231, s[16:19], s34 offen offset:3072 sc1
    s_add_u32 s34, s34, 4096
    v_mfma_f32_16x16x32_bf16 v[12:15], a[8:11], a[28:31], v[12:15]
    s_waitcnt lgkmcnt(4)
    v_mfma_f32_16x16x32_bf16 v[28:31], a[12:15], a[28:31], v[28:31]
    ds_read_b64_tr_b16 a[8:9], v229 offset:64
    v_mfma_f32_16x16x32_bf16 v[24:27], a[12:15], a[24:27], v[24:27]
    ds_read_b64_tr_b16 a[10:11], v229 offset:3648
    v_mfma_f32_16x16x32_bf16 v[20:23], a[12:15], a[20:23], v[20:23]
    buffer_load_dwordx4 a[76:79], v231, s[16:19], s35 offen offset:3072 sc1
    s_add_u32 s35, s35, 4096
    v_mfma_f32_16x16x32_bf16 v[16:19], a[12:15], a[16:19], v[16:19]
    s_waitcnt lgkmcnt(4)
    v_mfma_f32_16x16x32_bf16 v[32:35], a[0:3], a[16:19], v[32:35]
    ds_read_b64_tr_b16 a[12:13], v229 offset:14400
    v_mfma_f32_16x16x32_bf16 v[36:39], a[0:3], a[20:23], v[36:39]
    ds_read_b64_tr_b16 a[14:15], v229 offset:17984
    s_xor_b32 s40, s40, 57344
    s_add_u32 s52, s50, s40
    s_mov_b32 m0, s52
    v_mfma_f32_16x16x32_bf16 v[40:43], a[0:3], a[24:27], v[40:43]
    buffer_load_dwordx4 v232, s[44:47], s51 offen offset:0  lds
    v_mfma_f32_16x16x32_bf16 v[44:47], a[0:3], a[28:31], v[44:47]
    s_waitcnt lgkmcnt(4)
    v_mfma_f32_16x16x32_bf16 v[60:63], a[4:7], a[28:31], v[60:63]
    ds_read_b64_tr_b16 a[0:1], v229 offset:96
    v_mfma_f32_16x16x32_bf16 v[56:59], a[4:7], a[24:27], v[56:59]
    ds_read_b64_tr_b16 a[2:3], v229 offset:3680
    v_mfma_f32_16x16x32_bf16 v[52:55], a[4:7], a[20:23], v[52:55]
    buffer_load_dwordx4 v233, s[44:47], s51 offen offset:1024  lds
    v_mfma_f32_16x16x32_bf16 v[48:51], a[4:7], a[16:19], v[48:51]
    s_waitcnt lgkmcnt(4)
    v_mfma_f32_16x16x32_bf16 v[64:67], a[8:11], a[16:19], v[64:67]
    ds_read_b64_tr_b16 a[4:5], v229 offset:14432
    v_mfma_f32_16x16x32_bf16 v[68:71], a[8:11], a[20:23], v[68:71]
    ds_read_b64_tr_b16 a[6:7], v229 offset:18016
    v_mfma_f32_16x16x32_bf16 v[72:75], a[8:11], a[24:27], v[72:75]
    buffer_load_dwordx4 v234, s[44:47], s51 offen offset:2048  lds
    v_mfma_f32_16x16x32_bf16 v[76:79], a[8:11], a[28:31], v[76:79]
    s_waitcnt lgkmcnt(4)
    v_mfma_f32_16x16x32_bf16 v[92:95], a[12:15], a[28:31], v[92:95]
    ds_read_b64_tr_b16 a[8:9], v229 offset:128
    v_mfma_f32_16x16x32_bf16 v[88:91], a[12:15], a[24:27], v[88:91]
    ds_read_b64_tr_b16 a[10:11], v229 offset:3712
    v_mfma_f32_16x16x32_bf16 v[84:87], a[12:15], a[20:23], v[84:87]
    buffer_load_dwordx4 v235, s[44:47], s51 offen offset:3072  lds
    v_mfma_f32_16x16x32_bf16 v[80:83], a[12:15], a[16:19], v[80:83]
    s_waitcnt lgkmcnt(4)
    v_mfma_f32_16x16x32_bf16 v[96:99], a[0:3], a[16:19], v[96:99]
    ds_read_b64_tr_b16 a[12:13], v229 offset:14464
    v_mfma_f32_16x16x32_bf16 v[100:103], a[0:3], a[20:23], v[100:103]
    ds_read_b64_tr_b16 a[14:15], v229 offset:18048
    s_add_u32 s52, s52, 4096
    s_mov_b32 m0, s52
    v_mfma_f32_16x16x32_bf16 v[104:107], a[0:3], a[24:27], v[104:107]
    buffer_load_dwordx4 v236, s[44:47], s51 offen offset:0  lds
    v_mfma_f32_16x16x32_bf16 v[108:111], a[0:3], a[28:31], v[108:111]
    s_waitcnt lgkmcnt(4)
    v_mfma_f32_16x16x32_bf16 v[124:127], a[4:7], a[28:31], v[124:127]
    ds_read_b64_tr_b16 a[0:1], v229 offset:160
    v_mfma_f32_16x16x32_bf16 v[120:123], a[4:7], a[24:27], v[120:123]
    ds_read_b64_tr_b16 a[2:3], v229 offset:3744
    v_mfma_f32_16x16x32_bf16 v[116:119], a[4:7], a[20:23], v[116:119]
    buffer_load_dwordx4 v237, s[44:47], s51 offen offset:1024  lds
    v_mfma_f32_16x16x32_bf16 v[112:115], a[4:7], a[16:19], v[112:115]
    s_waitcnt lgkmcnt(4)
    v_mfma_f32_16x16x32_bf16 v[128:131], a[8:11], a[16:19], v[128:131]
    ds_read_b64_tr_b16 a[4:5], v229 offset:14496
    v_mfma_f32_16x16x32_bf16 v[132:135], a[8:11], a[20:23], v[132:135]
    ds_read_b64_tr_b16 a[6:7], v229 offset:18080
    v_mfma_f32_16x16x32_bf16 v[136:139], a[8:11], a[24:27], v[136:139]
    buffer_load_dwordx4 v238, s[44:47], s51 offen offset:2048  lds
    s_add_u32 s51, s51, 458752
    v_mfma_f32_16x16x32_bf16 v[140:143], a[8:11], a[28:31], v[140:143]
    s_waitcnt lgkmcnt(4)
    v_mfma_f32_16x16x32_bf16 v[156:159], a[12:15], a[28:31], v[156:159]
    ds_read_b64_tr_b16 a[8:9], v230 offset:7168
    v_mfma_f32_16x16x32_bf16 v[152:155], a[12:15], a[24:27], v[152:155]
    ds_read_b64_tr_b16 a[10:11], v230 offset:10752
    v_mfma_f32_16x16x32_bf16 v[148:151], a[12:15], a[20:23], v[148:151]
    v_mfma_f32_16x16x32_bf16 v[144:147], a[12:15], a[16:19], v[144:147]
    s_waitcnt lgkmcnt(4)
    v_mfma_f32_16x16x32_bf16 v[160:163], a[0:3], a[16:19], v[160:163]
    ds_read_b64_tr_b16 a[12:13], v230 offset:21504
    v_mfma_f32_16x16x32_bf16 v[164:167], a[0:3], a[20:23], v[164:167]
    ds_read_b64_tr_b16 a[14:15], v230 offset:25088
    v_mfma_f32_16x16x32_bf16 v[168:171], a[0:3], a[24:27], v[168:171]
    v_mfma_f32_16x16x32_bf16 v[172:175], a[0:3], a[28:31], v[172:175]
    s_waitcnt lgkmcnt(4)
    v_mfma_f32_16x16x32_bf16 v[188:191], a[4:7], a[28:31], v[188:191]
    ds_read_b64_tr_b16 a[0:1], v229 offset:7168
    v_mfma_f32_16x16x32_bf16 v[184:187], a[4:7], a[24:27], v[184:187]
    ds_read_b64_tr_b16 a[2:3], v229 offset:10752
    v_mfma_f32_16x16x32_bf16 v[180:183], a[4:7], a[20:23], v[180:183]
    v_mfma_f32_16x16x32_bf16 v[176:179], a[4:7], a[16:19], v[176:179]
    s_waitcnt vmcnt(22) lgkmcnt(4)
    v_mfma_f32_16x16x32_bf16 v[192:195], a[8:11], a[32:35], v[192:195]
    ds_read_b64_tr_b16 a[4:5], v229 offset:21504
    v_mfma_f32_16x16x32_bf16 v[196:199], a[8:11], a[36:39], v[196:199]
    ds_read_b64_tr_b16 a[6:7], v229 offset:25088
    v_mfma_f32_16x16x32_bf16 v[200:203], a[8:11], a[40:43], v[200:203]
    buffer_load_dwordx4 a[16:19], v231, s[16:19], s32 offen offset:0 sc1
    v_mfma_f32_16x16x32_bf16 v[204:207], a[8:11], a[44:47], v[204:207]
    s_waitcnt lgkmcnt(4)
    v_mfma_f32_16x16x32_bf16 v[220:223], a[12:15], a[44:47], v[220:223]
    ds_read_b64_tr_b16 a[8:9], v229 offset:7200
    v_mfma_f32_16x16x32_bf16 v[216:219], a[12:15], a[40:43], v[216:219]
    ds_read_b64_tr_b16 a[10:11], v229 offset:10784
    v_mfma_f32_16x16x32_bf16 v[212:215], a[12:15], a[36:39], v[212:215]
    buffer_load_dwordx4 a[20:23], v231, s[16:19], s33 offen offset:0 sc1
    v_mfma_f32_16x16x32_bf16 v[208:211], a[12:15], a[32:35], v[208:211]
    s_waitcnt lgkmcnt(4)
    v_mfma_f32_16x16x32_bf16 v[0:3], a[0:3], a[32:35], v[0:3]
    ds_read_b64_tr_b16 a[12:13], v229 offset:21536
    v_mfma_f32_16x16x32_bf16 v[4:7], a[0:3], a[36:39], v[4:7]
    ds_read_b64_tr_b16 a[14:15], v229 offset:25120
    v_mfma_f32_16x16x32_bf16 v[8:11], a[0:3], a[40:43], v[8:11]
    buffer_load_dwordx4 a[24:27], v231, s[16:19], s34 offen offset:0 sc1
    v_mfma_f32_16x16x32_bf16 v[12:15], a[0:3], a[44:47], v[12:15]
    s_waitcnt lgkmcnt(4)
    v_mfma_f32_16x16x32_bf16 v[28:31], a[4:7], a[44:47], v[28:31]
    ds_read_b64_tr_b16 a[0:1], v229 offset:7232
    v_mfma_f32_16x16x32_bf16 v[24:27], a[4:7], a[40:43], v[24:27]
    ds_read_b64_tr_b16 a[2:3], v229 offset:10816
    v_mfma_f32_16x16x32_bf16 v[20:23], a[4:7], a[36:39], v[20:23]
    buffer_load_dwordx4 a[28:31], v231, s[16:19], s35 offen offset:0 sc1
    v_mfma_f32_16x16x32_bf16 v[16:19], a[4:7], a[32:35], v[16:19]
    s_waitcnt lgkmcnt(4)
    v_mfma_f32_16x16x32_bf16 v[32:35], a[8:11], a[32:35], v[32:35]
    ds_read_b64_tr_b16 a[4:5], v229 offset:21568
    v_mfma_f32_16x16x32_bf16 v[36:39], a[8:11], a[36:39], v[36:39]
    ds_read_b64_tr_b16 a[6:7], v229 offset:25152
    v_mfma_f32_16x16x32_bf16 v[40:43], a[8:11], a[40:43], v[40:43]
    buffer_load_dword v243, v242, s[44:47], s38 offen
    buffer_load_dword v243, v244, s[20:23], s24 offen
    s_add_u32 s38, s38, 917504
    s_add_u32 s24, s24, 0x100000
    v_mfma_f32_16x16x32_bf16 v[44:47], a[8:11], a[44:47], v[44:47]
    s_waitcnt lgkmcnt(4)
    v_mfma_f32_16x16x32_bf16 v[60:63], a[12:15], a[44:47], v[60:63]
    ds_read_b64_tr_b16 a[8:9], v229 offset:7264
    v_mfma_f32_16x16x32_bf16 v[56:59], a[12:15], a[40:43], v[56:59]
    ds_read_b64_tr_b16 a[10:11], v229 offset:10848
    v_mfma_f32_16x16x32_bf16 v[52:55], a[12:15], a[36:39], v[52:55]
    v_mfma_f32_16x16x32_bf16 v[48:51], a[12:15], a[32:35], v[48:51]
    s_waitcnt lgkmcnt(4)
    v_mfma_f32_16x16x32_bf16 v[64:67], a[0:3], a[32:35], v[64:67]
    ds_read_b64_tr_b16 a[12:13], v229 offset:21600
    v_mfma_f32_16x16x32_bf16 v[68:71], a[0:3], a[36:39], v[68:71]
    ds_read_b64_tr_b16 a[14:15], v229 offset:25184
    v_mfma_f32_16x16x32_bf16 v[72:75], a[0:3], a[40:43], v[72:75]
    v_mfma_f32_16x16x32_bf16 v[76:79], a[0:3], a[44:47], v[76:79]
    s_waitcnt lgkmcnt(4)
    v_mfma_f32_16x16x32_bf16 v[92:95], a[4:7], a[44:47], v[92:95]
    ds_read_b64_tr_b16 a[0:1], v229 offset:7296
    v_mfma_f32_16x16x32_bf16 v[88:91], a[4:7], a[40:43], v[88:91]
    ds_read_b64_tr_b16 a[2:3], v229 offset:10880
    v_mfma_f32_16x16x32_bf16 v[84:87], a[4:7], a[36:39], v[84:87]
    v_mfma_f32_16x16x32_bf16 v[80:83], a[4:7], a[32:35], v[80:83]
    s_waitcnt lgkmcnt(4)
    v_mfma_f32_16x16x32_bf16 v[96:99], a[8:11], a[32:35], v[96:99]
    ds_read_b64_tr_b16 a[4:5], v229 offset:21632
    v_mfma_f32_16x16x32_bf16 v[100:103], a[8:11], a[36:39], v[100:103]
    ds_read_b64_tr_b16 a[6:7], v229 offset:25216
    v_mfma_f32_16x16x32_bf16 v[104:107], a[8:11], a[40:43], v[104:107]
    v_mfma_f32_16x16x32_bf16 v[108:111], a[8:11], a[44:47], v[108:111]
    s_waitcnt lgkmcnt(4)
    v_mfma_f32_16x16x32_bf16 v[124:127], a[12:15], a[44:47], v[124:127]
    ds_read_b64_tr_b16 a[8:9], v229 offset:7328
    v_mfma_f32_16x16x32_bf16 v[120:123], a[12:15], a[40:43], v[120:123]
    ds_read_b64_tr_b16 a[10:11], v229 offset:10912
    v_mfma_f32_16x16x32_bf16 v[116:119], a[12:15], a[36:39], v[116:119]
    v_mfma_f32_16x16x32_bf16 v[112:115], a[12:15], a[32:35], v[112:115]
    s_waitcnt lgkmcnt(4)
    v_mfma_f32_16x16x32_bf16 v[128:131], a[0:3], a[32:35], v[128:131]
    ds_read_b64_tr_b16 a[12:13], v229 offset:21664
    v_mfma_f32_16x16x32_bf16 v[132:135], a[0:3], a[36:39], v[132:135]
    ds_read_b64_tr_b16 a[14:15], v229 offset:25248
    v_mfma_f32_16x16x32_bf16 v[136:139], a[0:3], a[40:43], v[136:139]
    v_mfma_f32_16x16x32_bf16 v[140:143], a[0:3], a[44:47], v[140:143]
    s_waitcnt lgkmcnt(4)
    v_mfma_f32_16x16x32_bf16 v[156:159], a[4:7], a[44:47], v[156:159]
    s_waitcnt vmcnt(21)
    s_barrier
    ds_read_b64_tr_b16 a[0:1], v230 offset:28672
    v_mfma_f32_16x16x32_bf16 v[152:155], a[4:7], a[40:43], v[152:155]
    ds_read_b64_tr_b16 a[2:3], v230 offset:32256
    v_mfma_f32_16x16x32_bf16 v[148:151], a[4:7], a[36:39], v[148:151]
    v_mfma_f32_16x16x32_bf16 v[144:147], a[4:7], a[32:35], v[144:147]
    s_waitcnt lgkmcnt(4)
    v_mfma_f32_16x16x32_bf16 v[160:163], a[8:11], a[32:35], v[160:163]
    ds_read_b64_tr_b16 a[4:5], v230 offset:43008
    v_mfma_f32_16x16x32_bf16 v[164:167], a[8:11], a[36:39], v[164:167]
    ds_read_b64_tr_b16 a[6:7], v230 offset:46592
    v_mfma_f32_16x16x32_bf16 v[168:171], a[8:11], a[40:43], v[168:171]
    v_mfma_f32_16x16x32_bf16 v[172:175], a[8:11], a[44:47], v[172:175]
    s_waitcnt lgkmcnt(4)
    v_mfma_f32_16x16x32_bf16 v[188:191], a[12:15], a[44:47], v[188:191]
    ds_read_b64_tr_b16 a[8:9], v229 offset:28672
    v_mfma_f32_16x16x32_bf16 v[184:187], a[12:15], a[40:43], v[184:187]
    ds_read_b64_tr_b16 a[10:11], v229 offset:32256
    v_mfma_f32_16x16x32_bf16 v[180:183], a[12:15], a[36:39], v[180:183]
    v_mfma_f32_16x16x32_bf16 v[176:179], a[12:15], a[32:35], v[176:179]
    s_waitcnt vmcnt(17) lgkmcnt(4)
    v_mfma_f32_16x16x32_bf16 v[192:195], a[0:3], a[48:51], v[192:195]
    ds_read_b64_tr_b16 a[12:13], v229 offset:43008
    v_mfma_f32_16x16x32_bf16 v[196:199], a[0:3], a[52:55], v[196:199]
    ds_read_b64_tr_b16 a[14:15], v229 offset:46592
    v_mfma_f32_16x16x32_bf16 v[200:203], a[0:3], a[56:59], v[200:203]
    buffer_load_dwordx4 a[32:35], v231, s[16:19], s32 offen offset:1024 sc1
    v_mfma_f32_16x16x32_bf16 v[204:207], a[0:3], a[60:63], v[204:207]
    s_waitcnt lgkmcnt(4)
    v_mfma_f32_16x16x32_bf16 v[220:223], a[4:7], a[60:63], v[220:223]
    ds_read_b64_tr_b16 a[0:1], v229 offset:28704
    v_mfma_f32_16x16x32_bf16 v[216:219], a[4:7], a[56:59], v[216:219]
    ds_read_b64_tr_b16 a[2:3], v229 offset:32288
    v_mfma_f32_16x16x32_bf16 v[212:215], a[4:7], a[52:55], v[212:215]
    buffer_load_dwordx4 a[36:39], v231, s[16:19], s33 offen offset:1024 sc1
    v_mfma_f32_16x16x32_bf16 v[208:211], a[4:7], a[48:51], v[208:211]
    s_waitcnt lgkmcnt(4)
    v_mfma_f32_16x16x32_bf16 v[0:3], a[8:11], a[48:51], v[0:3]
    ds_read_b64_tr_b16 a[4:5], v229 offset:43040
    v_mfma_f32_16x16x32_bf16 v[4:7], a[8:11], a[52:55], v[4:7]
    ds_read_b64_tr_b16 a[6:7], v229 offset:46624
    v_mfma_f32_16x16x32_bf16 v[8:11], a[8:11], a[56:59], v[8:11]
    buffer_load_dwordx4 a[40:43], v231, s[16:19], s34 offen offset:1024 sc1
    v_mfma_f32_16x16x32_bf16 v[12:15], a[8:11], a[60:63], v[12:15]
    s_waitcnt lgkmcnt(4)
    v_mfma_f32_16x16x32_bf16 v[28:31], a[12:15], a[60:63], v[28:31]
    ds_read_b64_tr_b16 a[8:9], v229 offset:28736
    v_mfma_f32_16x16x32_bf16 v[24:27], a[12:15], a[56:59], v[24:27]
    ds_read_b64_tr_b16 a[10:11], v229 offset:32320
    v_mfma_f32_16x16x32_bf16 v[20:23], a[12:15], a[52:55], v[20:23]
    buffer_load_dwordx4 a[44:47], v231, s[16:19], s35 offen offset:1024 sc1
    v_mfma_f32_16x16x32_bf16 v[16:19], a[12:15], a[48:51], v[16:19]
    s_waitcnt lgkmcnt(4)
    v_mfma_f32_16x16x32_bf16 v[32:35], a[0:3], a[48:51], v[32:35]
    ds_read_b64_tr_b16 a[12:13], v229 offset:43072
    v_mfma_f32_16x16x32_bf16 v[36:39], a[0:3], a[52:55], v[36:39]
    ds_read_b64_tr_b16 a[14:15], v229 offset:46656
    s_add_u32 s52, s52, 24576
    s_mov_b32 m0, s52
    v_mfma_f32_16x16x32_bf16 v[40:43], a[0:3], a[56:59], v[40:43]
    buffer_load_dwordx4 v232, s[44:47], s51 offen offset:0  lds
    v_mfma_f32_16x16x32_bf16 v[44:47], a[0:3], a[60:63], v[44:47]
    s_waitcnt lgkmcnt(4)
    v_mfma_f32_16x16x32_bf16 v[60:63], a[4:7], a[60:63], v[60:63]
    ds_read_b64_tr_b16 a[0:1], v229 offset:28768
    v_mfma_f32_16x16x32_bf16 v[56:59], a[4:7], a[56:59], v[56:59]
    ds_read_b64_tr_b16 a[2:3], v229 offset:32352
    v_mfma_f32_16x16x32_bf16 v[52:55], a[4:7], a[52:55], v[52:55]
    buffer_load_dwordx4 v233, s[44:47], s51 offen offset:1024  lds
    v_mfma_f32_16x16x32_bf16 v[48:51], a[4:7], a[48:51], v[48:51]
    s_waitcnt lgkmcnt(4)
    v_mfma_f32_16x16x32_bf16 v[64:67], a[8:11], a[48:51], v[64:67]
    ds_read_b64_tr_b16 a[4:5], v229 offset:43104
    v_mfma_f32_16x16x32_bf16 v[68:71], a[8:11], a[52:55], v[68:71]
    ds_read_b64_tr_b16 a[6:7], v229 offset:46688
    v_mfma_f32_16x16x32_bf16 v[72:75], a[8:11], a[56:59], v[72:75]
    buffer_load_dwordx4 v234, s[44:47], s51 offen offset:2048  lds
    v_mfma_f32_16x16x32_bf16 v[76:79], a[8:11], a[60:63], v[76:79]
    s_waitcnt lgkmcnt(4)
    v_mfma_f32_16x16x32_bf16 v[92:95], a[12:15], a[60:63], v[92:95]
    ds_read_b64_tr_b16 a[8:9], v229 offset:28800
    v_mfma_f32_16x16x32_bf16 v[88:91], a[12:15], a[56:59], v[88:91]
    ds_read_b64_tr_b16 a[10:11], v229 offset:32384
    v_mfma_f32_16x16x32_bf16 v[84:87], a[12:15], a[52:55], v[84:87]
    buffer_load_dwordx4 v235, s[44:47], s51 offen offset:3072  lds
    v_mfma_f32_16x16x32_bf16 v[80:83], a[12:15], a[48:51], v[80:83]
    s_waitcnt lgkmcnt(4)
    v_mfma_f32_16x16x32_bf16 v[96:99], a[0:3], a[48:51], v[96:99]
    ds_read_b64_tr_b16 a[12:13], v229 offset:43136
    v_mfma_f32_16x16x32_bf16 v[100:103], a[0:3], a[52:55], v[100:103]
    ds_read_b64_tr_b16 a[14:15], v229 offset:46720
    s_add_u32 s52, s52, 4096
    s_mov_b32 m0, s52
    v_mfma_f32_16x16x32_bf16 v[104:107], a[0:3], a[56:59], v[104:107]
    buffer_load_dwordx4 v236, s[44:47], s51 offen offset:0  lds
    v_mfma_f32_16x16x32_bf16 v[108:111], a[0:3], a[60:63], v[108:111]
    s_waitcnt lgkmcnt(4)
    v_mfma_f32_16x16x32_bf16 v[124:127], a[4:7], a[60:63], v[124:127]
    ds_read_b64_tr_b16 a[0:1], v229 offset:28832
    v_mfma_f32_16x16x32_bf16 v[120:123], a[4:7], a[56:59], v[120:123]
    ds_read_b64_tr_b16 a[2:3], v229 offset:32416
    v_mfma_f32_16x16x32_bf16 v[116:119], a[4:7], a[52:55], v[116:119]
    buffer_load_dwordx4 v237, s[44:47], s51 offen offset:1024  lds
    v_mfma_f32_16x16x32_bf16 v[112:115], a[4:7], a[48:51], v[112:115]
    s_waitcnt lgkmcnt(4)
    v_mfma_f32_16x16x32_bf16 v[128:131], a[8:11], a[48:51], v[128:131]
    ds_read_b64_tr_b16 a[4:5], v229 offset:43168
    v_mfma_f32_16x16x32_bf16 v[132:135], a[8:11], a[52:55], v[132:135]
    ds_read_b64_tr_b16 a[6:7], v229 offset:46752
    v_mfma_f32_16x16x32_bf16 v[136:139], a[8:11], a[56:59], v[136:139]
    buffer_load_dwordx4 v238, s[44:47], s51 offen offset:2048  lds
    s_add_u32 s51, s51, 458752
    v_mfma_f32_16x16x32_bf16 v[140:143], a[8:11], a[60:63], v[140:143]
    s_waitcnt lgkmcnt(4)
    v_mfma_f32_16x16x32_bf16 v[156:159], a[12:15], a[60:63], v[156:159]
    ds_read_b64_tr_b16 a[8:9], v230 offset:35840
    v_mfma_f32_16x16x32_bf16 v[152:155], a[12:15], a[56:59], v[152:155]
    ds_read_b64_tr_b16 a[10:11], v230 offset:39424
    v_mfma_f32_16x16x32_bf16 v[148:151], a[12:15], a[52:55], v[148:151]
    v_mfma_f32_16x16x32_bf16 v[144:147], a[12:15], a[48:51], v[144:147]
    s_waitcnt lgkmcnt(4)
    v_mfma_f32_16x16x32_bf16 v[160:163], a[0:3], a[48:51], v[160:163]
    ds_read_b64_tr_b16 a[12:13], v230 offset:50176
    v_mfma_f32_16x16x32_bf16 v[164:167], a[0:3], a[52:55], v[164:167]
    ds_read_b64_tr_b16 a[14:15], v230 offset:53760
    v_mfma_f32_16x16x32_bf16 v[168:171], a[0:3], a[56:59], v[168:171]
    v_mfma_f32_16x16x32_bf16 v[172:175], a[0:3], a[60:63], v[172:175]
    s_waitcnt lgkmcnt(4)
    v_mfma_f32_16x16x32_bf16 v[188:191], a[4:7], a[60:63], v[188:191]
    ds_read_b64_tr_b16 a[0:1], v229 offset:35840
    v_mfma_f32_16x16x32_bf16 v[184:187], a[4:7], a[56:59], v[184:187]
    ds_read_b64_tr_b16 a[2:3], v229 offset:39424
    v_mfma_f32_16x16x32_bf16 v[180:183], a[4:7], a[52:55], v[180:183]
    v_mfma_f32_16x16x32_bf16 v[176:179], a[4:7], a[48:51], v[176:179]
    s_waitcnt vmcnt(24) lgkmcnt(4)
    v_mfma_f32_16x16x32_bf16 v[192:195], a[8:11], a[64:67], v[192:195]
    ds_read_b64_tr_b16 a[4:5], v229 offset:50176
    v_mfma_f32_16x16x32_bf16 v[196:199], a[8:11], a[68:71], v[196:199]
    ds_read_b64_tr_b16 a[6:7], v229 offset:53760
    v_mfma_f32_16x16x32_bf16 v[200:203], a[8:11], a[72:75], v[200:203]
    buffer_load_dwordx4 a[48:51], v231, s[16:19], s32 offen offset:2048 sc1
    v_mfma_f32_16x16x32_bf16 v[204:207], a[8:11], a[76:79], v[204:207]
    s_waitcnt lgkmcnt(4)
    v_mfma_f32_16x16x32_bf16 v[220:223], a[12:15], a[76:79], v[220:223]
    ds_read_b64_tr_b16 a[8:9], v229 offset:35872
    v_mfma_f32_16x16x32_bf16 v[216:219], a[12:15], a[72:75], v[216:219]
    ds_read_b64_tr_b16 a[10:11], v229 offset:39456
    v_mfma_f32_16x16x32_bf16 v[212:215], a[12:15], a[68:71], v[212:215]
    buffer_load_dwordx4 a[52:55], v231, s[16:19], s33 offen offset:2048 sc1
    v_mfma_f32_16x16x32_bf16 v[208:211], a[12:15], a[64:67], v[208:211]
    s_waitcnt lgkmcnt(4)
    v_mfma_f32_16x16x32_bf16 v[0:3], a[0:3], a[64:67], v[0:3]
    ds_read_b64_tr_b16 a[12:13], v229 offset:50208
    v_mfma_f32_16x16x32_bf16 v[4:7], a[0:3], a[68:71], v[4:7]
    ds_read_b64_tr_b16 a[14:15], v229 offset:53792
    v_mfma_f32_16x16x32_bf16 v[8:11], a[0:3], a[72:75], v[8:11]
    buffer_load_dwordx4 a[56:59], v231, s[16:19], s34 offen offset:2048 sc1
    v_mfma_f32_16x16x32_bf16 v[12:15], a[0:3], a[76:79], v[12:15]
    s_waitcnt lgkmcnt(4)
    v_mfma_f32_16x16x32_bf16 v[28:31], a[4:7], a[76:79], v[28:31]
    ds_read_b64_tr_b16 a[0:1], v229 offset:35904
    v_mfma_f32_16x16x32_bf16 v[24:27], a[4:7], a[72:75], v[24:27]
    ds_read_b64_tr_b16 a[2:3], v229 offset:39488
    v_mfma_f32_16x16x32_bf16 v[20:23], a[4:7], a[68:71], v[20:23]
    buffer_load_dwordx4 a[60:63], v231, s[16:19], s35 offen offset:2048 sc1
    v_mfma_f32_16x16x32_bf16 v[16:19], a[4:7], a[64:67], v[16:19]
    s_waitcnt lgkmcnt(4)
    v_mfma_f32_16x16x32_bf16 v[32:35], a[8:11], a[64:67], v[32:35]
    ds_read_b64_tr_b16 a[4:5], v229 offset:50240
    v_mfma_f32_16x16x32_bf16 v[36:39], a[8:11], a[68:71], v[36:39]
    ds_read_b64_tr_b16 a[6:7], v229 offset:53824
    v_mfma_f32_16x16x32_bf16 v[40:43], a[8:11], a[72:75], v[40:43]
    v_mfma_f32_16x16x32_bf16 v[44:47], a[8:11], a[76:79], v[44:47]
    s_waitcnt lgkmcnt(4)
    v_mfma_f32_16x16x32_bf16 v[60:63], a[12:15], a[76:79], v[60:63]
    ds_read_b64_tr_b16 a[8:9], v229 offset:35936
    v_mfma_f32_16x16x32_bf16 v[56:59], a[12:15], a[72:75], v[56:59]
    ds_read_b64_tr_b16 a[10:11], v229 offset:39520
    v_mfma_f32_16x16x32_bf16 v[52:55], a[12:15], a[68:71], v[52:55]
    v_mfma_f32_16x16x32_bf16 v[48:51], a[12:15], a[64:67], v[48:51]
    s_waitcnt lgkmcnt(4)
    v_mfma_f32_16x16x32_bf16 v[64:67], a[0:3], a[64:67], v[64:67]
    ds_read_b64_tr_b16 a[12:13], v229 offset:50272
    v_mfma_f32_16x16x32_bf16 v[68:71], a[0:3], a[68:71], v[68:71]
    ds_read_b64_tr_b16 a[14:15], v229 offset:53856
    v_mfma_f32_16x16x32_bf16 v[72:75], a[0:3], a[72:75], v[72:75]
    v_mfma_f32_16x16x32_bf16 v[76:79], a[0:3], a[76:79], v[76:79]
    s_waitcnt lgkmcnt(4)
    v_mfma_f32_16x16x32_bf16 v[92:95], a[4:7], a[76:79], v[92:95]
    ds_read_b64_tr_b16 a[0:1], v229 offset:35968
    v_mfma_f32_16x16x32_bf16 v[88:91], a[4:7], a[72:75], v[88:91]
    ds_read_b64_tr_b16 a[2:3], v229 offset:39552
    v_mfma_f32_16x16x32_bf16 v[84:87], a[4:7], a[68:71], v[84:87]
    v_mfma_f32_16x16x32_bf16 v[80:83], a[4:7], a[64:67], v[80:83]
    s_waitcnt lgkmcnt(4)
    v_mfma_f32_16x16x32_bf16 v[96:99], a[8:11], a[64:67], v[96:99]
    ds_read_b64_tr_b16 a[4:5], v229 offset:50304
    v_mfma_f32_16x16x32_bf16 v[100:103], a[8:11], a[68:71], v[100:103]
    ds_read_b64_tr_b16 a[6:7], v229 offset:53888
    v_mfma_f32_16x16x32_bf16 v[104:107], a[8:11], a[72:75], v[104:107]
    v_mfma_f32_16x16x32_bf16 v[108:111], a[8:11], a[76:79], v[108:111]
    s_waitcnt lgkmcnt(4)
    v_mfma_f32_16x16x32_bf16 v[124:127], a[12:15], a[76:79], v[124:127]
    ds_read_b64_tr_b16 a[8:9], v229 offset:36000
    v_mfma_f32_16x16x32_bf16 v[120:123], a[12:15], a[72:75], v[120:123]
    ds_read_b64_tr_b16 a[10:11], v229 offset:39584
    v_mfma_f32_16x16x32_bf16 v[116:119], a[12:15], a[68:71], v[116:119]
    v_mfma_f32_16x16x32_bf16 v[112:115], a[12:15], a[64:67], v[112:115]
    s_waitcnt lgkmcnt(4)
    v_mfma_f32_16x16x32_bf16 v[128:131], a[0:3], a[64:67], v[128:131]
    ds_read_b64_tr_b16 a[12:13], v229 offset:50336
    v_mfma_f32_16x16x32_bf16 v[132:135], a[0:3], a[68:71], v[132:135]
    ds_read_b64_tr_b16 a[14:15], v229 offset:53920
    v_mfma_f32_16x16x32_bf16 v[136:139], a[0:3], a[72:75], v[136:139]
    v_mfma_f32_16x16x32_bf16 v[140:143], a[0:3], a[76:79], v[140:143]
    s_waitcnt lgkmcnt(4)
    v_mfma_f32_16x16x32_bf16 v[156:159], a[4:7], a[76:79], v[156:159]
    s_waitcnt vmcnt(21)
    s_barrier
    v_xor_b32 v229, 57344, v229
    v_xor_b32 v230, 57344, v230
    ds_read_b64_tr_b16 a[0:1], v230 offset:0
    v_mfma_f32_16x16x32_bf16 v[152:155], a[4:7], a[72:75], v[152:155]
    ds_read_b64_tr_b16 a[2:3], v230 offset:3584
    v_mfma_f32_16x16x32_bf16 v[148:151], a[4:7], a[68:71], v[148:151]
    v_mfma_f32_16x16x32_bf16 v[144:147], a[4:7], a[64:67], v[144:147]
    s_waitcnt lgkmcnt(4)
    v_mfma_f32_16x16x32_bf16 v[160:163], a[8:11], a[64:67], v[160:163]
    ds_read_b64_tr_b16 a[4:5], v230 offset:14336
    v_mfma_f32_16x16x32_bf16 v[164:167], a[8:11], a[68:71], v[164:167]
    ds_read_b64_tr_b16 a[6:7], v230 offset:17920
    v_mfma_f32_16x16x32_bf16 v[168:171], a[8:11], a[72:75], v[168:171]
    v_mfma_f32_16x16x32_bf16 v[172:175], a[8:11], a[76:79], v[172:175]
    s_waitcnt lgkmcnt(4)
    v_mfma_f32_16x16x32_bf16 v[188:191], a[12:15], a[76:79], v[188:191]
    ds_read_b64_tr_b16 a[8:9], v229 offset:0
    v_mfma_f32_16x16x32_bf16 v[184:187], a[12:15], a[72:75], v[184:187]
    ds_read_b64_tr_b16 a[10:11], v229 offset:3584
    v_mfma_f32_16x16x32_bf16 v[180:183], a[12:15], a[68:71], v[180:183]
    s_add_u32 s39, s39, 1
    s_cmp_lg_u32 s39, 7
    v_mfma_f32_16x16x32_bf16 v[176:179], a[12:15], a[64:67], v[176:179]
    s_cbranch_scc1 sequential_preLN__spectral_gfnet__glu_gated_bilinear__prompt_kernel_loop4
    buffer_load_dwordx4 a[64:67], v231, s[16:19], s32 offen offset:3072 sc1
    s_add_u32 s32, s32, 4096
    buffer_load_dwordx4 a[68:71], v231, s[16:19], s33 offen offset:3072 sc1
    s_add_u32 s33, s33, 4096
    buffer_load_dwordx4 a[72:75], v231, s[16:19], s34 offen offset:3072 sc1
    s_add_u32 s34, s34, 4096
    buffer_load_dwordx4 a[76:79], v231, s[16:19], s35 offen offset:3072 sc1
    s_add_u32 s35, s35, 4096
    s_add_u32 s16, s10, 26214400
    s_addc_u32 s17, s11, 0
    s_mov_b32 s18, 14680064
    s_mov_b32 s19, 0x20000
    ds_read_b64_tr_b16 a[8:9], v230 offset:7168
    ds_read_b64_tr_b16 a[10:11], v230 offset:10752
    s_waitcnt vmcnt(21) lgkmcnt(4)
    v_mfma_f32_16x16x32_bf16 v[192:195], a[0:3], a[16:19], v[192:195]
    ds_read_b64_tr_b16 a[12:13], v230 offset:21504
    s_cmp_eq_u32 s60, 0
    v_mfma_f32_16x16x32_bf16 v[196:199], a[0:3], a[20:23], v[196:199]
    ds_read_b64_tr_b16 a[14:15], v230 offset:25088
    s_cselect_b32 s53, 4, 0
    v_mfma_f32_16x16x32_bf16 v[200:203], a[0:3], a[24:27], v[200:203]
    s_lshl_b32 s53, s53, 17
    s_cmp_eq_u32 s60, 1
    v_mfma_f32_16x16x32_bf16 v[204:207], a[0:3], a[28:31], v[204:207]
    s_cselect_b32 s54, 5, 1
    s_waitcnt lgkmcnt(4)
    v_mfma_f32_16x16x32_bf16 v[220:223], a[4:7], a[28:31], v[220:223]
    s_getpc_b64 s[4:5]
sequential_preLN__spectral_gfnet__glu_gated_bilinear__prompt_kernel_pc2:
    s_lshr_b32 s63, s2, 3
    s_lshl_b32 s63, s63, 2
    s_add_u32 s63, s63, s3
    v_mov_b32 v224, s63
    v_lshlrev_b32 v224, 7, v224
    v_min_u32 v224, code_end-sequential_preLN__spectral_gfnet__glu_gated_bilinear__prompt_kernel_pc2-4, v224
    global_load_dword v225, v224, s[4:5]
    ds_read_b64_tr_b16 a[0:1], v229 offset:0
    s_lshl_b32 s54, s54, 17
    v_mfma_f32_16x16x32_bf16 v[216:219], a[4:7], a[24:27], v[216:219]
    ds_read_b64_tr_b16 a[2:3], v229 offset:3584
    s_cmp_eq_u32 s60, 2
    v_mfma_f32_16x16x32_bf16 v[212:215], a[4:7], a[20:23], v[212:215]
    s_cselect_b32 s55, 6, 2
    s_lshl_b32 s55, s55, 17
    v_mfma_f32_16x16x32_bf16 v[208:211], a[4:7], a[16:19], v[208:211]
    s_cmp_eq_u32 s60, 3
    s_waitcnt vmcnt(16) lgkmcnt(4)
    v_mfma_f32_16x16x32_bf16 v[192:195], a[8:11], a[32:35], v[192:195]
    ds_read_b64_tr_b16 a[4:5], v229 offset:14336
    s_cselect_b32 s62, 7, 3
    v_mfma_f32_16x16x32_bf16 v[196:199], a[8:11], a[36:39], v[196:199]
    ds_read_b64_tr_b16 a[6:7], v229 offset:17920
    s_lshl_b32 s62, s62, 17
    v_mfma_f32_16x16x32_bf16 v[200:203], a[8:11], a[40:43], v[200:203]
    s_add_u32 s40, s60, 28
    s_lshl_b32 s40, s40, 17
    v_mfma_f32_16x16x32_bf16 v[204:207], a[8:11], a[44:47], v[204:207]
    s_lshl_b32 s36, s60, 17
    s_waitcnt lgkmcnt(4)
    v_mfma_f32_16x16x32_bf16 v[220:223], a[12:15], a[44:47], v[220:223]
    ds_read_b64_tr_b16 a[8:9], v229 offset:7168
    v_mfma_f32_16x16x32_bf16 v[216:219], a[12:15], a[40:43], v[216:219]
    ds_read_b64_tr_b16 a[10:11], v229 offset:10752
    v_mfma_f32_16x16x32_bf16 v[212:215], a[12:15], a[36:39], v[212:215]
    v_mfma_f32_16x16x32_bf16 v[208:211], a[12:15], a[32:35], v[208:211]
    s_waitcnt lgkmcnt(4)
    v_mfma_f32_16x16x32_bf16 v[0:3], a[0:3], a[16:19], v[0:3]
    ds_read_b64_tr_b16 a[12:13], v229 offset:21504
    v_mfma_f32_16x16x32_bf16 v[4:7], a[0:3], a[20:23], v[4:7]
    ds_read_b64_tr_b16 a[14:15], v229 offset:25088
    v_mfma_f32_16x16x32_bf16 v[8:11], a[0:3], a[24:27], v[8:11]
    v_mfma_f32_16x16x32_bf16 v[12:15], a[0:3], a[28:31], v[12:15]
    s_waitcnt lgkmcnt(4)
    v_mfma_f32_16x16x32_bf16 v[28:31], a[4:7], a[28:31], v[28:31]
    s_waitcnt vmcnt(9)
    s_barrier
    ds_read_b64_tr_b16 a[0:1], v230 offset:28672
    s_add_u32 s63, s61, 0
    v_mfma_f32_16x16x32_bf16 v[24:27], a[4:7], a[24:27], v[24:27]
    ds_read_b64_tr_b16 a[2:3], v230 offset:32256
    s_mov_b32 m0, s63
    v_mfma_f32_16x16x32_bf16 v[20:23], a[4:7], a[20:23], v[20:23]
    buffer_load_dwordx4 v246, s[12:15], s53 offen offset:0 lds
    v_mfma_f32_16x16x32_bf16 v[16:19], a[4:7], a[16:19], v[16:19]
    s_waitcnt lgkmcnt(4)
    v_mfma_f32_16x16x32_bf16 v[0:3], a[8:11], a[32:35], v[0:3]
    ds_read_b64_tr_b16 a[4:5], v230 offset:43008
    buffer_load_dwordx4 v247, s[12:15], s53 offen offset:1024 lds
    v_mfma_f32_16x16x32_bf16 v[4:7], a[8:11], a[36:39], v[4:7]
    ds_read_b64_tr_b16 a[6:7], v230 offset:46592
    v_mfma_f32_16x16x32_bf16 v[8:11], a[8:11], a[40:43], v[8:11]
    v_mfma_f32_16x16x32_bf16 v[12:15], a[8:11], a[44:47], v[12:15]
    s_waitcnt lgkmcnt(4)
    v_mfma_f32_16x16x32_bf16 v[28:31], a[12:15], a[44:47], v[28:31]
    ds_read_b64_tr_b16 a[8:9], v229 offset:28672
    buffer_load_dwordx4 v248, s[12:15], s53 offen offset:2048 lds
    v_mfma_f32_16x16x32_bf16 v[24:27], a[12:15], a[40:43], v[24:27]
    ds_read_b64_tr_b16 a[10:11], v229 offset:32256
    v_mfma_f32_16x16x32_bf16 v[20:23], a[12:15], a[36:39], v[20:23]
    v_mfma_f32_16x16x32_bf16 v[16:19], a[12:15], a[32:35], v[16:19]
    s_waitcnt vmcnt(8) lgkmcnt(4)
    v_mfma_f32_16x16x32_bf16 v[192:195], a[0:3], a[48:51], v[192:195]
    ds_read_b64_tr_b16 a[12:13], v229 offset:43008
    buffer_load_dwordx4 v249, s[12:15], s53 offen offset:3072 lds
    v_mfma_f32_16x16x32_bf16 v[196:199], a[0:3], a[52:55], v[196:199]
    ds_read_b64_tr_b16 a[14:15], v229 offset:46592
    s_add_u32 s53, s53, 524288
    v_mfma_f32_16x16x32_bf16 v[200:203], a[0:3], a[56:59], v[200:203]
    s_cmp_eq_u32 s53, s40
    s_cselect_b32 s53, s36, s53
    v_mfma_f32_16x16x32_bf16 v[204:207], a[0:3], a[60:63], v[204:207]
    s_add_u32 s63, s61, 16384
    s_waitcnt lgkmcnt(4)
    v_mfma_f32_16x16x32_bf16 v[220:223], a[4:7], a[60:63], v[220:223]
    ds_read_b64_tr_b16 a[0:1], v230 offset:35840
    s_mov_b32 m0, s63
    v_mfma_f32_16x16x32_bf16 v[216:219], a[4:7], a[56:59], v[216:219]
    ds_read_b64_tr_b16 a[2:3], v230 offset:39424
    buffer_load_dwordx4 v246, s[12:15], s54 offen offset:0 lds
    v_mfma_f32_16x16x32_bf16 v[212:215], a[4:7], a[52:55], v[212:215]
    v_mfma_f32_16x16x32_bf16 v[208:211], a[4:7], a[48:51], v[208:211]
    s_waitcnt lgkmcnt(4)
    v_mfma_f32_16x16x32_bf16 v[0:3], a[8:11], a[48:51], v[0:3]
    ds_read_b64_tr_b16 a[4:5], v230 offset:50176
    buffer_load_dwordx4 v247, s[12:15], s54 offen offset:1024 lds
    v_mfma_f32_16x16x32_bf16 v[4:7], a[8:11], a[52:55], v[4:7]
    ds_read_b64_tr_b16 a[6:7], v230 offset:53760
    v_mfma_f32_16x16x32_bf16 v[8:11], a[8:11], a[56:59], v[8:11]
    v_mfma_f32_16x16x32_bf16 v[12:15], a[8:11], a[60:63], v[12:15]
    s_waitcnt lgkmcnt(4)
    v_mfma_f32_16x16x32_bf16 v[28:31], a[12:15], a[60:63], v[28:31]
    ds_read_b64_tr_b16 a[8:9], v229 offset:35840
    buffer_load_dwordx4 v248, s[12:15], s54 offen offset:2048 lds
    v_mfma_f32_16x16x32_bf16 v[24:27], a[12:15], a[56:59], v[24:27]
    ds_read_b64_tr_b16 a[10:11], v229 offset:39424
    v_mfma_f32_16x16x32_bf16 v[20:23], a[12:15], a[52:55], v[20:23]
    v_mfma_f32_16x16x32_bf16 v[16:19], a[12:15], a[48:51], v[16:19]
    s_waitcnt vmcnt(8) lgkmcnt(4)
    v_mfma_f32_16x16x32_bf16 v[192:195], a[0:3], a[64:67], v[192:195]
    ds_read_b64_tr_b16 a[12:13], v229 offset:50176
    buffer_load_dwordx4 v249, s[12:15], s54 offen offset:3072 lds
    v_mfma_f32_16x16x32_bf16 v[196:199], a[0:3], a[68:71], v[196:199]
    ds_read_b64_tr_b16 a[14:15], v229 offset:53760
    s_add_u32 s54, s54, 524288
    v_mfma_f32_16x16x32_bf16 v[200:203], a[0:3], a[72:75], v[200:203]
    s_cmp_eq_u32 s54, s40
    s_cselect_b32 s54, s36, s54
    v_mfma_f32_16x16x32_bf16 v[204:207], a[0:3], a[76:79], v[204:207]
    s_add_u32 s63, s61, 32768
    s_waitcnt lgkmcnt(4)
    v_mfma_f32_16x16x32_bf16 v[220:223], a[4:7], a[76:79], v[220:223]
    ds_read_b64_tr_b16 a[0:1], v229 offset:32
    s_mov_b32 m0, s63
    v_mfma_f32_16x16x32_bf16 v[216:219], a[4:7], a[72:75], v[216:219]
    ds_read_b64_tr_b16 a[2:3], v229 offset:3616
    buffer_load_dwordx4 v246, s[12:15], s55 offen offset:0 lds
    v_mfma_f32_16x16x32_bf16 v[212:215], a[4:7], a[68:71], v[212:215]
    v_mfma_f32_16x16x32_bf16 v[208:211], a[4:7], a[64:67], v[208:211]
    s_waitcnt lgkmcnt(4)
    v_mfma_f32_16x16x32_bf16 v[0:3], a[8:11], a[64:67], v[0:3]
    ds_read_b64_tr_b16 a[4:5], v229 offset:14368
    s_nop 0
    v_mfma_f32_16x16x32_bf16 v[4:7], a[8:11], a[68:71], v[4:7]
    ds_read_b64_tr_b16 a[6:7], v229 offset:17952
    s_nop 0
    v_mfma_f32_16x16x32_bf16 v[8:11], a[8:11], a[72:75], v[8:11]
    s_nop 0
    v_mul_f32 v192, v192, v208
    v_mfma_f32_16x16x32_bf16 v[12:15], a[8:11], a[76:79], v[12:15]
    v_mul_f32 v193, v193, v209
    s_waitcnt lgkmcnt(4)
    v_mfma_f32_16x16x32_bf16 v[28:31], a[12:15], a[76:79], v[28:31]
    ds_read_b64_tr_b16 a[8:9], v229 offset:7200
    buffer_load_dwordx4 v247, s[12:15], s55 offen offset:1024 lds
    v_mfma_f32_16x16x32_bf16 v[24:27], a[12:15], a[72:75], v[24:27]
    ds_read_b64_tr_b16 a[10:11], v229 offset:10784
    v_mul_f32 v194, v194, v210
    v_mfma_f32_16x16x32_bf16 v[20:23], a[12:15], a[68:71], v[20:23]
    v_mul_f32 v195, v195, v211
    v_cvt_pk_bf16_f32 v192, v192, v193
    v_mfma_f32_16x16x32_bf16 v[16:19], a[12:15], a[64:67], v[16:19]
    v_cvt_pk_bf16_f32 v193, v194, v195
    s_waitcnt lgkmcnt(4)
    v_mfma_f32_16x16x32_bf16 v[32:35], a[0:3], a[16:19], v[32:35]
    ds_read_b64_tr_b16 a[12:13], v229 offset:21536
    v_mul_f32 v196, v196, v212
    v_mfma_f32_16x16x32_bf16 v[36:39], a[0:3], a[20:23], v[36:39]
    ds_read_b64_tr_b16 a[14:15], v229 offset:25120
    v_mul_f32 v197, v197, v213
    v_mfma_f32_16x16x32_bf16 v[40:43], a[0:3], a[24:27], v[40:43]
    v_mul_f32 v198, v198, v214
    v_mul_f32 v199, v199, v215
    v_mfma_f32_16x16x32_bf16 v[44:47], a[0:3], a[28:31], v[44:47]
    v_cvt_pk_bf16_f32 v194, v196, v197
    s_waitcnt lgkmcnt(4)
    v_mfma_f32_16x16x32_bf16 v[60:63], a[4:7], a[28:31], v[60:63]
    ds_read_b64_tr_b16 a[0:1], v229 offset:28704
    v_cvt_pk_bf16_f32 v195, v198, v199
    v_mfma_f32_16x16x32_bf16 v[56:59], a[4:7], a[24:27], v[56:59]
    ds_read_b64_tr_b16 a[2:3], v229 offset:32288
    v_permlane16_swap_b32 v192, v194
    v_mfma_f32_16x16x32_bf16 v[52:55], a[4:7], a[20:23], v[52:55]
    v_permlane16_swap_b32 v193, v195
    buffer_store_dwordx4 v[192:195], v251, s[16:19], s41 offen sc1
    v_mfma_f32_16x16x32_bf16 v[48:51], a[4:7], a[16:19], v[48:51]
    v_mul_f32 v200, v200, v216
    s_waitcnt lgkmcnt(4)
    v_mfma_f32_16x16x32_bf16 v[32:35], a[8:11], a[32:35], v[32:35]
    ds_read_b64_tr_b16 a[4:5], v229 offset:43040
    v_mul_f32 v201, v201, v217
    v_mfma_f32_16x16x32_bf16 v[36:39], a[8:11], a[36:39], v[36:39]
    ds_read_b64_tr_b16 a[6:7], v229 offset:46624
    v_mul_f32 v202, v202, v218
    v_mfma_f32_16x16x32_bf16 v[40:43], a[8:11], a[40:43], v[40:43]
    v_mul_f32 v203, v203, v219
    v_cvt_pk_bf16_f32 v200, v200, v201
    v_mfma_f32_16x16x32_bf16 v[44:47], a[8:11], a[44:47], v[44:47]
    v_cvt_pk_bf16_f32 v201, v202, v203
    s_waitcnt lgkmcnt(4)
    v_mfma_f32_16x16x32_bf16 v[60:63], a[12:15], a[44:47], v[60:63]
    ds_read_b64_tr_b16 a[8:9], v229 offset:35872
    buffer_load_dwordx4 v248, s[12:15], s55 offen offset:2048 lds
    v_mfma_f32_16x16x32_bf16 v[56:59], a[12:15], a[40:43], v[56:59]
    ds_read_b64_tr_b16 a[10:11], v229 offset:39456
    v_mul_f32 v204, v204, v220
    v_mfma_f32_16x16x32_bf16 v[52:55], a[12:15], a[36:39], v[52:55]
    v_mul_f32 v205, v205, v221
    v_mul_f32 v206, v206, v222
    v_mfma_f32_16x16x32_bf16 v[48:51], a[12:15], a[32:35], v[48:51]
    v_mul_f32 v207, v207, v223
    s_waitcnt lgkmcnt(4)
    v_mfma_f32_16x16x32_bf16 v[32:35], a[0:3], a[48:51], v[32:35]
    ds_read_b64_tr_b16 a[12:13], v229 offset:50208
    v_cvt_pk_bf16_f32 v202, v204, v205
    v_mfma_f32_16x16x32_bf16 v[36:39], a[0:3], a[52:55], v[36:39]
    ds_read_b64_tr_b16 a[14:15], v229 offset:53792
    v_cvt_pk_bf16_f32 v203, v206, v207
    v_mfma_f32_16x16x32_bf16 v[40:43], a[0:3], a[56:59], v[40:43]
    v_permlane16_swap_b32 v200, v202
    v_permlane16_swap_b32 v201, v203
    v_mfma_f32_16x16x32_bf16 v[44:47], a[0:3], a[60:63], v[44:47]
    buffer_store_dwordx4 v[200:203], v251, s[16:19], s42 offen sc1
    s_waitcnt lgkmcnt(4)
    v_mfma_f32_16x16x32_bf16 v[60:63], a[4:7], a[60:63], v[60:63]
    ds_read_b64_tr_b16 a[0:1], v229 offset:64
    buffer_load_dwordx4 v249, s[12:15], s55 offen offset:3072 lds
    v_mfma_f32_16x16x32_bf16 v[56:59], a[4:7], a[56:59], v[56:59]
    ds_read_b64_tr_b16 a[2:3], v229 offset:3648
    v_mul_f32 v0, v0, v16
    v_mfma_f32_16x16x32_bf16 v[52:55], a[4:7], a[52:55], v[52:55]
    v_mul_f32 v1, v1, v17
    v_mul_f32 v2, v2, v18
    v_mfma_f32_16x16x32_bf16 v[48:51], a[4:7], a[48:51], v[48:51]
    v_mul_f32 v3, v3, v19
    s_waitcnt lgkmcnt(4)
    v_mfma_f32_16x16x32_bf16 v[32:35], a[8:11], a[64:67], v[32:35]
    ds_read_b64_tr_b16 a[4:5], v229 offset:14400
    v_cvt_pk_bf16_f32 v0, v0, v1
    v_mfma_f32_16x16x32_bf16 v[36:39], a[8:11], a[68:71], v[36:39]
    ds_read_b64_tr_b16 a[6:7], v229 offset:17984
    v_cvt_pk_bf16_f32 v1, v2, v3
    v_mfma_f32_16x16x32_bf16 v[40:43], a[8:11], a[72:75], v[40:43]
    v_mul_f32 v4, v4, v20
    v_mul_f32 v5, v5, v21
    v_mfma_f32_16x16x32_bf16 v[44:47], a[8:11], a[76:79], v[44:47]
    v_mul_f32 v6, v6, v22
    s_waitcnt lgkmcnt(4)
    v_mfma_f32_16x16x32_bf16 v[60:63], a[12:15], a[76:79], v[60:63]
    ds_read_b64_tr_b16 a[8:9], v229 offset:7232
    s_add_u32 s55, s55, 524288
    v_mfma_f32_16x16x32_bf16 v[56:59], a[12:15], a[72:75], v[56:59]
    ds_read_b64_tr_b16 a[10:11], v229 offset:10816
    s_cmp_eq_u32 s55, s40
    v_mfma_f32_16x16x32_bf16 v[52:55], a[12:15], a[68:71], v[52:55]
    s_cselect_b32 s55, s36, s55
    v_mul_f32 v7, v7, v23
    v_mfma_f32_16x16x32_bf16 v[48:51], a[12:15], a[64:67], v[48:51]
    v_cvt_pk_bf16_f32 v4, v4, v5
    s_waitcnt lgkmcnt(4)
    v_mfma_f32_16x16x32_bf16 v[64:67], a[0:3], a[16:19], v[64:67]
    ds_read_b64_tr_b16 a[12:13], v229 offset:21568
    v_cvt_pk_bf16_f32 v5, v6, v7
    v_mfma_f32_16x16x32_bf16 v[68:71], a[0:3], a[20:23], v[68:71]
    ds_read_b64_tr_b16 a[14:15], v229 offset:25152
    v_mul_f32 v8, v8, v24
    v_mfma_f32_16x16x32_bf16 v[72:75], a[0:3], a[24:27], v[72:75]
    v_mul_f32 v9, v9, v25
    v_mul_f32 v10, v10, v26
    v_mfma_f32_16x16x32_bf16 v[76:79], a[0:3], a[28:31], v[76:79]
    v_mul_f32 v11, v11, v27
    s_waitcnt lgkmcnt(4)
    v_mfma_f32_16x16x32_bf16 v[92:95], a[4:7], a[28:31], v[92:95]
    ds_read_b64_tr_b16 a[0:1], v229 offset:28736
    v_cvt_pk_bf16_f32 v8, v8, v9
    v_mfma_f32_16x16x32_bf16 v[88:91], a[4:7], a[24:27], v[88:91]
    ds_read_b64_tr_b16 a[2:3], v229 offset:32320
    v_cvt_pk_bf16_f32 v9, v10, v11
    v_mfma_f32_16x16x32_bf16 v[84:87], a[4:7], a[20:23], v[84:87]
    v_mul_f32 v12, v12, v28
    v_mul_f32 v13, v13, v29
    v_mfma_f32_16x16x32_bf16 v[80:83], a[4:7], a[16:19], v[80:83]
    v_mul_f32 v14, v14, v30
    s_waitcnt lgkmcnt(4)
    v_mfma_f32_16x16x32_bf16 v[64:67], a[8:11], a[32:35], v[64:67]
    ds_read_b64_tr_b16 a[4:5], v229 offset:43072
    v_mul_f32 v15, v15, v31
    v_mfma_f32_16x16x32_bf16 v[68:71], a[8:11], a[36:39], v[68:71]
    ds_read_b64_tr_b16 a[6:7], v229 offset:46656
    v_cvt_pk_bf16_f32 v12, v12, v13
    v_mfma_f32_16x16x32_bf16 v[72:75], a[8:11], a[40:43], v[72:75]
    v_cvt_pk_bf16_f32 v13, v14, v15
    v_mul_f32 v32, v32, v48
    v_mfma_f32_16x16x32_bf16 v[76:79], a[8:11], a[44:47], v[76:79]
    v_mul_f32 v33, v33, v49
    s_waitcnt lgkmcnt(4)
    v_mfma_f32_16x16x32_bf16 v[92:95], a[12:15], a[44:47], v[92:95]
    ds_read_b64_tr_b16 a[8:9], v229 offset:35904
    v_mul_f32 v34, v34, v50
    v_mfma_f32_16x16x32_bf16 v[88:91], a[12:15], a[40:43], v[88:91]
    ds_read_b64_tr_b16 a[10:11], v229 offset:39488
    v_mul_f32 v35, v35, v51
    v_mfma_f32_16x16x32_bf16 v[84:87], a[12:15], a[36:39], v[84:87]
    v_cvt_pk_bf16_f32 v2, v32, v33
    v_cvt_pk_bf16_f32 v3, v34, v35
    v_mfma_f32_16x16x32_bf16 v[80:83], a[12:15], a[32:35], v[80:83]
    v_permlane16_swap_b32 v0, v2
    s_waitcnt lgkmcnt(4)
    v_mfma_f32_16x16x32_bf16 v[64:67], a[0:3], a[48:51], v[64:67]
    ds_read_b64_tr_b16 a[12:13], v229 offset:50240
    v_permlane16_swap_b32 v1, v3
    v_mfma_f32_16x16x32_bf16 v[68:71], a[0:3], a[52:55], v[68:71]
    ds_read_b64_tr_b16 a[14:15], v229 offset:53824
    buffer_store_dwordx4 v[0:3], v250, s[16:19], s37 offen offset:0 sc1
    v_mfma_f32_16x16x32_bf16 v[72:75], a[0:3], a[56:59], v[72:75]
    v_mul_f32 v36, v36, v52
    v_mul_f32 v37, v37, v53
    v_mfma_f32_16x16x32_bf16 v[76:79], a[0:3], a[60:63], v[76:79]
    v_mul_f32 v38, v38, v54
    s_waitcnt lgkmcnt(4)
    v_mfma_f32_16x16x32_bf16 v[92:95], a[4:7], a[60:63], v[92:95]
    ds_read_b64_tr_b16 a[0:1], v229 offset:96
    v_mul_f32 v39, v39, v55
    v_mfma_f32_16x16x32_bf16 v[88:91], a[4:7], a[56:59], v[88:91]
    ds_read_b64_tr_b16 a[2:3], v229 offset:3680
    v_cvt_pk_bf16_f32 v6, v36, v37
    v_mfma_f32_16x16x32_bf16 v[84:87], a[4:7], a[52:55], v[84:87]
    v_cvt_pk_bf16_f32 v7, v38, v39
    v_permlane16_swap_b32 v4, v6
    v_mfma_f32_16x16x32_bf16 v[80:83], a[4:7], a[48:51], v[80:83]
    v_permlane16_swap_b32 v5, v7
    s_waitcnt lgkmcnt(4)
    v_mfma_f32_16x16x32_bf16 v[64:67], a[8:11], a[64:67], v[64:67]
    ds_read_b64_tr_b16 a[4:5], v229 offset:14432
    buffer_store_dwordx4 v[4:7], v250, s[16:19], s28 offen offset:0 sc1
    v_mfma_f32_16x16x32_bf16 v[68:71], a[8:11], a[68:71], v[68:71]
    ds_read_b64_tr_b16 a[6:7], v229 offset:18016
    v_mul_f32 v40, v40, v56
    v_mfma_f32_16x16x32_bf16 v[72:75], a[8:11], a[72:75], v[72:75]
    v_mul_f32 v41, v41, v57
    v_mul_f32 v42, v42, v58
    v_mfma_f32_16x16x32_bf16 v[76:79], a[8:11], a[76:79], v[76:79]
    v_mul_f32 v43, v43, v59
    s_waitcnt lgkmcnt(4)
    v_mfma_f32_16x16x32_bf16 v[92:95], a[12:15], a[76:79], v[92:95]
    ds_read_b64_tr_b16 a[8:9], v229 offset:7264
    v_cvt_pk_bf16_f32 v10, v40, v41
    v_mfma_f32_16x16x32_bf16 v[88:91], a[12:15], a[72:75], v[88:91]
    ds_read_b64_tr_b16 a[10:11], v229 offset:10848
    v_cvt_pk_bf16_f32 v11, v42, v43
    v_mfma_f32_16x16x32_bf16 v[84:87], a[12:15], a[68:71], v[84:87]
    v_permlane16_swap_b32 v8, v10
    v_permlane16_swap_b32 v9, v11
    v_mfma_f32_16x16x32_bf16 v[80:83], a[12:15], a[64:67], v[80:83]
    buffer_store_dwordx4 v[8:11], v250, s[16:19], s29 offen offset:0 sc1
    s_waitcnt lgkmcnt(4)
    v_mfma_f32_16x16x32_bf16 v[96:99], a[0:3], a[16:19], v[96:99]
    ds_read_b64_tr_b16 a[12:13], v229 offset:21600
    v_mul_f32 v44, v44, v60
    v_mfma_f32_16x16x32_bf16 v[100:103], a[0:3], a[20:23], v[100:103]
    ds_read_b64_tr_b16 a[14:15], v229 offset:25184
    v_mul_f32 v45, v45, v61
    v_mfma_f32_16x16x32_bf16 v[104:107], a[0:3], a[24:27], v[104:107]
    v_mul_f32 v46, v46, v62
    v_mul_f32 v47, v47, v63
    v_mfma_f32_16x16x32_bf16 v[108:111], a[0:3], a[28:31], v[108:111]
    v_cvt_pk_bf16_f32 v14, v44, v45
    s_waitcnt lgkmcnt(4)
    v_mfma_f32_16x16x32_bf16 v[124:127], a[4:7], a[28:31], v[124:127]
    ds_read_b64_tr_b16 a[0:1], v229 offset:28768
    v_cvt_pk_bf16_f32 v15, v46, v47
    v_mfma_f32_16x16x32_bf16 v[120:123], a[4:7], a[24:27], v[120:123]
    ds_read_b64_tr_b16 a[2:3], v229 offset:32352
    v_permlane16_swap_b32 v12, v14
    v_mfma_f32_16x16x32_bf16 v[116:119], a[4:7], a[20:23], v[116:119]
    v_permlane16_swap_b32 v13, v15
    buffer_store_dwordx4 v[12:15], v250, s[16:19], s30 offen offset:0 sc1
    v_mfma_f32_16x16x32_bf16 v[112:115], a[4:7], a[16:19], v[112:115]
    v_mul_f32 v64, v64, v80
    s_waitcnt lgkmcnt(4)
    v_mfma_f32_16x16x32_bf16 v[96:99], a[8:11], a[32:35], v[96:99]
    ds_read_b64_tr_b16 a[4:5], v229 offset:43104
    v_mul_f32 v65, v65, v81
    v_mfma_f32_16x16x32_bf16 v[100:103], a[8:11], a[36:39], v[100:103]
    ds_read_b64_tr_b16 a[6:7], v229 offset:46688
    v_mul_f32 v66, v66, v82
    v_mfma_f32_16x16x32_bf16 v[104:107], a[8:11], a[40:43], v[104:107]
    v_mul_f32 v67, v67, v83
    v_cvt_pk_bf16_f32 v64, v64, v65
    v_mfma_f32_16x16x32_bf16 v[108:111], a[8:11], a[44:47], v[108:111]
    v_cvt_pk_bf16_f32 v65, v66, v67
    s_waitcnt lgkmcnt(4)
    v_mfma_f32_16x16x32_bf16 v[124:127], a[12:15], a[44:47], v[124:127]
    ds_read_b64_tr_b16 a[8:9], v229 offset:35936
    v_mul_f32 v68, v68, v84
    v_mfma_f32_16x16x32_bf16 v[120:123], a[12:15], a[40:43], v[120:123]
    ds_read_b64_tr_b16 a[10:11], v229 offset:39520
    v_mul_f32 v69, v69, v85
    v_mfma_f32_16x16x32_bf16 v[116:119], a[12:15], a[36:39], v[116:119]
    v_mul_f32 v70, v70, v86
    v_mul_f32 v71, v71, v87
    v_mfma_f32_16x16x32_bf16 v[112:115], a[12:15], a[32:35], v[112:115]
    v_cvt_pk_bf16_f32 v68, v68, v69
    s_waitcnt lgkmcnt(4)
    v_mfma_f32_16x16x32_bf16 v[96:99], a[0:3], a[48:51], v[96:99]
    ds_read_b64_tr_b16 a[12:13], v229 offset:50272
    v_cvt_pk_bf16_f32 v69, v70, v71
    v_mfma_f32_16x16x32_bf16 v[100:103], a[0:3], a[52:55], v[100:103]
    ds_read_b64_tr_b16 a[14:15], v229 offset:53856
    v_mul_f32 v72, v72, v88
    v_mfma_f32_16x16x32_bf16 v[104:107], a[0:3], a[56:59], v[104:107]
    v_mul_f32 v73, v73, v89
    v_mul_f32 v74, v74, v90
    v_mfma_f32_16x16x32_bf16 v[108:111], a[0:3], a[60:63], v[108:111]
    v_mul_f32 v75, v75, v91
    s_waitcnt lgkmcnt(4)
    v_mfma_f32_16x16x32_bf16 v[124:127], a[4:7], a[60:63], v[124:127]
    ds_read_b64_tr_b16 a[0:1], v229 offset:128
    v_cvt_pk_bf16_f32 v72, v72, v73
    v_mfma_f32_16x16x32_bf16 v[120:123], a[4:7], a[56:59], v[120:123]
    ds_read_b64_tr_b16 a[2:3], v229 offset:3712
    v_cvt_pk_bf16_f32 v73, v74, v75
    v_mfma_f32_16x16x32_bf16 v[116:119], a[4:7], a[52:55], v[116:119]
    v_mul_f32 v76, v76, v92
    v_mul_f32 v77, v77, v93
    v_mfma_f32_16x16x32_bf16 v[112:115], a[4:7], a[48:51], v[112:115]
    v_mul_f32 v78, v78, v94
    s_waitcnt lgkmcnt(4)
    v_mfma_f32_16x16x32_bf16 v[96:99], a[8:11], a[64:67], v[96:99]
    ds_read_b64_tr_b16 a[4:5], v229 offset:14464
    v_mul_f32 v79, v79, v95
    v_mfma_f32_16x16x32_bf16 v[100:103], a[8:11], a[68:71], v[100:103]
    ds_read_b64_tr_b16 a[6:7], v229 offset:18048
    v_cvt_pk_bf16_f32 v76, v76, v77
    v_mfma_f32_16x16x32_bf16 v[104:107], a[8:11], a[72:75], v[104:107]
    v_cvt_pk_bf16_f32 v77, v78, v79
    v_mfma_f32_16x16x32_bf16 v[108:111], a[8:11], a[76:79], v[108:111]
    s_waitcnt lgkmcnt(4)
    v_mfma_f32_16x16x32_bf16 v[124:127], a[12:15], a[76:79], v[124:127]
    ds_read_b64_tr_b16 a[8:9], v229 offset:7296
    v_mfma_f32_16x16x32_bf16 v[120:123], a[12:15], a[72:75], v[120:123]
    ds_read_b64_tr_b16 a[10:11], v229 offset:10880
    v_mfma_f32_16x16x32_bf16 v[116:119], a[12:15], a[68:71], v[116:119]
    v_mfma_f32_16x16x32_bf16 v[112:115], a[12:15], a[64:67], v[112:115]
    s_waitcnt lgkmcnt(4)
    v_mfma_f32_16x16x32_bf16 v[128:131], a[0:3], a[16:19], v[128:131]
    ds_read_b64_tr_b16 a[12:13], v229 offset:21632
    s_nop 0
    v_mfma_f32_16x16x32_bf16 v[132:135], a[0:3], a[20:23], v[132:135]
    ds_read_b64_tr_b16 a[14:15], v229 offset:25216
    s_nop 0
    v_mfma_f32_16x16x32_bf16 v[136:139], a[0:3], a[24:27], v[136:139]
    s_nop 0
    v_mul_f32 v96, v96, v112
    v_mfma_f32_16x16x32_bf16 v[140:143], a[0:3], a[28:31], v[140:143]
    v_mul_f32 v97, v97, v113
    s_waitcnt lgkmcnt(4)
    v_mfma_f32_16x16x32_bf16 v[156:159], a[4:7], a[28:31], v[156:159]
    ds_read_b64_tr_b16 a[0:1], v229 offset:28800
    v_mul_f32 v98, v98, v114
    v_mfma_f32_16x16x32_bf16 v[152:155], a[4:7], a[24:27], v[152:155]
    ds_read_b64_tr_b16 a[2:3], v229 offset:32384
    v_mul_f32 v99, v99, v115
    v_mfma_f32_16x16x32_bf16 v[148:151], a[4:7], a[20:23], v[148:151]
    v_cvt_pk_bf16_f32 v66, v96, v97
    v_cvt_pk_bf16_f32 v67, v98, v99
    v_mfma_f32_16x16x32_bf16 v[144:147], a[4:7], a[16:19], v[144:147]
    v_permlane16_swap_b32 v64, v66
    s_waitcnt lgkmcnt(4)
    v_mfma_f32_16x16x32_bf16 v[128:131], a[8:11], a[32:35], v[128:131]
    ds_read_b64_tr_b16 a[4:5], v229 offset:43136
    v_permlane16_swap_b32 v65, v67
    v_mfma_f32_16x16x32_bf16 v[132:135], a[8:11], a[36:39], v[132:135]
    ds_read_b64_tr_b16 a[6:7], v229 offset:46720
    buffer_store_dwordx4 v[64:67], v250, s[16:19], s37 offen offset:1024 sc1
    v_mfma_f32_16x16x32_bf16 v[136:139], a[8:11], a[40:43], v[136:139]
    v_mul_f32 v100, v100, v116
    v_mul_f32 v101, v101, v117
    v_mfma_f32_16x16x32_bf16 v[140:143], a[8:11], a[44:47], v[140:143]
    v_mul_f32 v102, v102, v118
    s_waitcnt lgkmcnt(4)
    v_mfma_f32_16x16x32_bf16 v[156:159], a[12:15], a[44:47], v[156:159]
    ds_read_b64_tr_b16 a[8:9], v229 offset:35968
    v_mul_f32 v103, v103, v119
    v_mfma_f32_16x16x32_bf16 v[152:155], a[12:15], a[40:43], v[152:155]
    ds_read_b64_tr_b16 a[10:11], v229 offset:39552
    v_cvt_pk_bf16_f32 v70, v100, v101
    v_mfma_f32_16x16x32_bf16 v[148:151], a[12:15], a[36:39], v[148:151]
    v_cvt_pk_bf16_f32 v71, v102, v103
    v_permlane16_swap_b32 v68, v70
    v_mfma_f32_16x16x32_bf16 v[144:147], a[12:15], a[32:35], v[144:147]
    v_permlane16_swap_b32 v69, v71
    s_waitcnt lgkmcnt(4)
    v_mfma_f32_16x16x32_bf16 v[128:131], a[0:3], a[48:51], v[128:131]
    ds_read_b64_tr_b16 a[12:13], v229 offset:50304
    buffer_store_dwordx4 v[68:71], v250, s[16:19], s28 offen offset:1024 sc1
    v_mfma_f32_16x16x32_bf16 v[132:135], a[0:3], a[52:55], v[132:135]
    ds_read_b64_tr_b16 a[14:15], v229 offset:53888
    v_mul_f32 v104, v104, v120
    v_mfma_f32_16x16x32_bf16 v[136:139], a[0:3], a[56:59], v[136:139]
    v_mul_f32 v105, v105, v121
    v_mul_f32 v106, v106, v122
    v_mfma_f32_16x16x32_bf16 v[140:143], a[0:3], a[60:63], v[140:143]
    v_mul_f32 v107, v107, v123
    s_waitcnt lgkmcnt(4)
    v_mfma_f32_16x16x32_bf16 v[156:159], a[4:7], a[60:63], v[156:159]
    ds_read_b64_tr_b16 a[0:1], v229 offset:160
    v_cvt_pk_bf16_f32 v74, v104, v105
    v_mfma_f32_16x16x32_bf16 v[152:155], a[4:7], a[56:59], v[152:155]
    ds_read_b64_tr_b16 a[2:3], v229 offset:3744
    v_cvt_pk_bf16_f32 v75, v106, v107
    v_mfma_f32_16x16x32_bf16 v[148:151], a[4:7], a[52:55], v[148:151]
    v_permlane16_swap_b32 v72, v74
    v_permlane16_swap_b32 v73, v75
    v_mfma_f32_16x16x32_bf16 v[144:147], a[4:7], a[48:51], v[144:147]
    buffer_store_dwordx4 v[72:75], v250, s[16:19], s29 offen offset:1024 sc1
    s_waitcnt lgkmcnt(4)
    v_mfma_f32_16x16x32_bf16 v[128:131], a[8:11], a[64:67], v[128:131]
    ds_read_b64_tr_b16 a[4:5], v229 offset:14496
    v_mul_f32 v108, v108, v124
    v_mfma_f32_16x16x32_bf16 v[132:135], a[8:11], a[68:71], v[132:135]
    ds_read_b64_tr_b16 a[6:7], v229 offset:18080
    v_mul_f32 v109, v109, v125
    v_mfma_f32_16x16x32_bf16 v[136:139], a[8:11], a[72:75], v[136:139]
    v_mul_f32 v110, v110, v126
    v_mul_f32 v111, v111, v127
    v_mfma_f32_16x16x32_bf16 v[140:143], a[8:11], a[76:79], v[140:143]
    v_cvt_pk_bf16_f32 v78, v108, v109
    s_waitcnt lgkmcnt(4)
    v_mfma_f32_16x16x32_bf16 v[156:159], a[12:15], a[76:79], v[156:159]
    ds_read_b64_tr_b16 a[8:9], v229 offset:7328
    v_cvt_pk_bf16_f32 v79, v110, v111
    v_mfma_f32_16x16x32_bf16 v[152:155], a[12:15], a[72:75], v[152:155]
    ds_read_b64_tr_b16 a[10:11], v229 offset:10912
    v_permlane16_swap_b32 v76, v78
    v_mfma_f32_16x16x32_bf16 v[148:151], a[12:15], a[68:71], v[148:151]
    v_permlane16_swap_b32 v77, v79
    buffer_store_dwordx4 v[76:79], v250, s[16:19], s30 offen offset:1024 sc1
    v_mfma_f32_16x16x32_bf16 v[144:147], a[12:15], a[64:67], v[144:147]
    s_waitcnt lgkmcnt(4)
    v_mfma_f32_16x16x32_bf16 v[160:163], a[0:3], a[16:19], v[160:163]
    ds_read_b64_tr_b16 a[12:13], v229 offset:21664
    s_nop 0
    v_mfma_f32_16x16x32_bf16 v[164:167], a[0:3], a[20:23], v[164:167]
    ds_read_b64_tr_b16 a[14:15], v229 offset:25248
    s_nop 0
    v_mfma_f32_16x16x32_bf16 v[168:171], a[0:3], a[24:27], v[168:171]
    s_nop 0
    v_mul_f32 v128, v128, v144
    v_mfma_f32_16x16x32_bf16 v[172:175], a[0:3], a[28:31], v[172:175]
    v_mul_f32 v129, v129, v145
    s_waitcnt lgkmcnt(4)
    v_mfma_f32_16x16x32_bf16 v[188:191], a[4:7], a[28:31], v[188:191]
    ds_read_b64_tr_b16 a[0:1], v229 offset:28832
    v_mul_f32 v130, v130, v146
    v_mfma_f32_16x16x32_bf16 v[184:187], a[4:7], a[24:27], v[184:187]
    ds_read_b64_tr_b16 a[2:3], v229 offset:32416
    v_mul_f32 v131, v131, v147
    v_mfma_f32_16x16x32_bf16 v[180:183], a[4:7], a[20:23], v[180:183]
    v_cvt_pk_bf16_f32 v128, v128, v129
    v_cvt_pk_bf16_f32 v129, v130, v131
    v_mfma_f32_16x16x32_bf16 v[176:179], a[4:7], a[16:19], v[176:179]
    v_mul_f32 v132, v132, v148
    s_waitcnt lgkmcnt(4)
    v_mfma_f32_16x16x32_bf16 v[160:163], a[8:11], a[32:35], v[160:163]
    ds_read_b64_tr_b16 a[4:5], v229 offset:43168
    v_mul_f32 v133, v133, v149
    v_mfma_f32_16x16x32_bf16 v[164:167], a[8:11], a[36:39], v[164:167]
    ds_read_b64_tr_b16 a[6:7], v229 offset:46752
    v_mul_f32 v134, v134, v150
    v_mfma_f32_16x16x32_bf16 v[168:171], a[8:11], a[40:43], v[168:171]
    v_mul_f32 v135, v135, v151
    v_cvt_pk_bf16_f32 v132, v132, v133
    v_mfma_f32_16x16x32_bf16 v[172:175], a[8:11], a[44:47], v[172:175]
    v_cvt_pk_bf16_f32 v133, v134, v135
    s_waitcnt lgkmcnt(4)
    v_mfma_f32_16x16x32_bf16 v[188:191], a[12:15], a[44:47], v[188:191]
    ds_read_b64_tr_b16 a[8:9], v229 offset:36000
    v_mul_f32 v136, v136, v152
    v_mfma_f32_16x16x32_bf16 v[184:187], a[12:15], a[40:43], v[184:187]
    ds_read_b64_tr_b16 a[10:11], v229 offset:39584
    v_mul_f32 v137, v137, v153
    v_mfma_f32_16x16x32_bf16 v[180:183], a[12:15], a[36:39], v[180:183]
    v_mul_f32 v138, v138, v154
    v_mul_f32 v139, v139, v155
    v_mfma_f32_16x16x32_bf16 v[176:179], a[12:15], a[32:35], v[176:179]
    v_cvt_pk_bf16_f32 v136, v136, v137
    s_waitcnt lgkmcnt(4)
    v_mfma_f32_16x16x32_bf16 v[160:163], a[0:3], a[48:51], v[160:163]
    ds_read_b64_tr_b16 a[12:13], v229 offset:50336
    v_cvt_pk_bf16_f32 v137, v138, v139
    v_mfma_f32_16x16x32_bf16 v[164:167], a[0:3], a[52:55], v[164:167]
    ds_read_b64_tr_b16 a[14:15], v229 offset:53920
    v_mul_f32 v140, v140, v156
    v_mfma_f32_16x16x32_bf16 v[168:171], a[0:3], a[56:59], v[168:171]
    v_mul_f32 v141, v141, v157
    v_mul_f32 v142, v142, v158
    v_mfma_f32_16x16x32_bf16 v[172:175], a[0:3], a[60:63], v[172:175]
    v_mul_f32 v143, v143, v159
    s_waitcnt lgkmcnt(4)
    v_mfma_f32_16x16x32_bf16 v[188:191], a[4:7], a[60:63], v[188:191]
    v_cvt_pk_bf16_f32 v140, v140, v141
    v_cvt_pk_bf16_f32 v141, v142, v143
    v_mfma_f32_16x16x32_bf16 v[184:187], a[4:7], a[56:59], v[184:187]
    v_mfma_f32_16x16x32_bf16 v[180:183], a[4:7], a[52:55], v[180:183]
    v_mfma_f32_16x16x32_bf16 v[176:179], a[4:7], a[48:51], v[176:179]
    s_waitcnt lgkmcnt(2)
    v_mfma_f32_16x16x32_bf16 v[160:163], a[8:11], a[64:67], v[160:163]
    v_mfma_f32_16x16x32_bf16 v[164:167], a[8:11], a[68:71], v[164:167]
    v_mfma_f32_16x16x32_bf16 v[168:171], a[8:11], a[72:75], v[168:171]
    v_mfma_f32_16x16x32_bf16 v[172:175], a[8:11], a[76:79], v[172:175]
    s_waitcnt lgkmcnt(0)
    v_mfma_f32_16x16x32_bf16 v[188:191], a[12:15], a[76:79], v[188:191]
    v_mfma_f32_16x16x32_bf16 v[184:187], a[12:15], a[72:75], v[184:187]
    v_mfma_f32_16x16x32_bf16 v[180:183], a[12:15], a[68:71], v[180:183]
    v_mfma_f32_16x16x32_bf16 v[176:179], a[12:15], a[64:67], v[176:179]
    s_nop 7
    v_pk_mul_f32 v[160:161], v[160:161], v[176:177]
    v_pk_mul_f32 v[162:163], v[162:163], v[178:179]
    v_cvt_pk_bf16_f32 v130, v160, v161
    v_cvt_pk_bf16_f32 v131, v162, v163
    s_nop 0
    v_permlane16_swap_b32 v128, v130
    v_permlane16_swap_b32 v129, v131
    buffer_store_dwordx4 v[128:131], v250, s[16:19], s37 offen offset:2048 sc1
    v_pk_mul_f32 v[164:165], v[164:165], v[180:181]
    v_pk_mul_f32 v[166:167], v[166:167], v[182:183]
    v_cvt_pk_bf16_f32 v134, v164, v165
    v_cvt_pk_bf16_f32 v135, v166, v167
    s_nop 0
    v_permlane16_swap_b32 v132, v134
    v_permlane16_swap_b32 v133, v135
    buffer_store_dwordx4 v[132:135], v250, s[16:19], s28 offen offset:2048 sc1
    v_pk_mul_f32 v[168:169], v[168:169], v[184:185]
    v_pk_mul_f32 v[170:171], v[170:171], v[186:187]
    v_cvt_pk_bf16_f32 v138, v168, v169
    v_cvt_pk_bf16_f32 v139, v170, v171
    s_nop 0
    v_permlane16_swap_b32 v136, v138
    v_permlane16_swap_b32 v137, v139
    buffer_store_dwordx4 v[136:139], v250, s[16:19], s29 offen offset:2048 sc1
    v_pk_mul_f32 v[172:173], v[172:173], v[188:189]
    v_pk_mul_f32 v[174:175], v[174:175], v[190:191]
    v_cvt_pk_bf16_f32 v142, v172, v173
    v_cvt_pk_bf16_f32 v143, v174, v175
    s_nop 0
    v_permlane16_swap_b32 v140, v142
    v_permlane16_swap_b32 v141, v143
    buffer_store_dwordx4 v[140:143], v250, s[16:19], s30 offen offset:2048 sc1
    s_lshl_b32 s28, s25, 3
    s_lshl_b32 s29, s3, 1
    s_add_u32 s28, s28, s29
    s_mul_i32 s29, s28, 114688
    s_mul_i32 s31, s26, 57344
    s_add_u32 s29, s29, s31
    s_add_u32 s31, s28, 0
    s_lshr_b32 s32, s31, 4
    s_lshl_b32 s32, s32, 8
    s_and_b32 s31, s31, 15
    s_lshl_b32 s31, s31, 2
    s_add_u32 s31, s31, s32
    v_bfe_u32 v241, v228, 3, 1
    v_lshlrev_b32 v241, 1, v241
    v_bfe_u32 v252, v228, 1, 2
    v_lshl_add_u32 v241, v252, 6, v241
    v_and_or_b32 v241, v228, 1, v241
    v_add_u32 v241, s31, v241
    v_lshlrev_b32 v176, 11, v241
    v_lshrrev_b32 v241, 4, v228
    v_lshl_add_u32 v178, v241, 4, v176
    v_bfe_u32 v241, v228, 4, 1
    v_lshl_add_u32 v176, v241, 5, v176
    v_lshrrev_b32 v241, 5, v228
    v_lshl_add_u32 v176, v241, 4, v176
    s_add_u32 s31, s28, 1
    s_lshr_b32 s32, s31, 4
    s_lshl_b32 s32, s32, 8
    s_and_b32 s31, s31, 15
    s_lshl_b32 s31, s31, 2
    s_add_u32 s31, s31, s32
    v_bfe_u32 v241, v228, 3, 1
    v_lshlrev_b32 v241, 1, v241
    v_bfe_u32 v252, v228, 1, 2
    v_lshl_add_u32 v241, v252, 6, v241
    v_and_or_b32 v241, v228, 1, v241
    v_add_u32 v241, s31, v241
    v_lshlrev_b32 v177, 11, v241
    v_lshrrev_b32 v241, 4, v228
    v_lshl_add_u32 v179, v241, 4, v177
    v_bfe_u32 v241, v228, 4, 1
    v_lshl_add_u32 v177, v241, 5, v177
    v_lshrrev_b32 v241, 5, v228
    v_lshl_add_u32 v177, v241, 4, v177
    s_add_u32 s44, s10, 20971520
    s_addc_u32 s45, s11, 0
    s_mov_b32 s46, 4194304
    s_mov_b32 s47, 0x20000
    s_lshl_b32 s33, s28, 15
    s_lshl_b32 s31, s27, 4
    s_add_u32 s33, s33, s31
    s_add_u32 s37, s33, 0x8000
    s_lshl_b32 s31, s28, 7
    s_add_u32 s31, s31, 15728640
    v_and_b32 v178, 15, v228
    v_lshl_add_u32 v178, v178, 3, s31
    v_lshrrev_b32 v241, 4, v228
    v_lshlrev_b32 v180, 11, v241
    v_and_b32 v241, 1, v241
    v_xor_b32 v241, s26, v241
    v_lshl_add_u32 v180, v241, 7, v180
    v_bfe_u32 v241, v228, 2, 2
    v_lshl_add_u32 v180, v241, 8, v180
    v_lshl_add_u32 v180, v241, 5, v180
    v_and_b32 v241, 3, v228
    v_lshl_add_u32 v180, v241, 3, v180
    v_xor_b32 v181, 32, v180
    v_xor_b32 v182, 64, v180
    v_xor_b32 v183, 96, v180
    v_xor_b32 v184, 128, v180
    v_xor_b32 v185, 160, v180
    v_xor_b32 v186, 192, v180
    v_xor_b32 v187, 224, v180
    v_mov_b32 v0, 0
    v_mov_b32 v1, 0
    v_mov_b32 v2, 0
    v_mov_b32 v3, 0
    v_mov_b32 v4, 0
    v_mov_b32 v5, 0
    v_mov_b32 v6, 0
    v_mov_b32 v7, 0
    v_mov_b32 v8, 0
    v_mov_b32 v9, 0
    v_mov_b32 v10, 0
    v_mov_b32 v11, 0
    v_mov_b32 v12, 0
    v_mov_b32 v13, 0
    v_mov_b32 v14, 0
    v_mov_b32 v15, 0
    v_mov_b32 v16, 0
    v_mov_b32 v17, 0
    v_mov_b32 v18, 0
    v_mov_b32 v19, 0
    v_mov_b32 v20, 0
    v_mov_b32 v21, 0
    v_mov_b32 v22, 0
    v_mov_b32 v23, 0
    v_mov_b32 v24, 0
    v_mov_b32 v25, 0
    v_mov_b32 v26, 0
    v_mov_b32 v27, 0
    v_mov_b32 v28, 0
    v_mov_b32 v29, 0
    v_mov_b32 v30, 0
    v_mov_b32 v31, 0
    v_mov_b32 v32, 0
    v_mov_b32 v33, 0
    v_mov_b32 v34, 0
    v_mov_b32 v35, 0
    v_mov_b32 v36, 0
    v_mov_b32 v37, 0
    v_mov_b32 v38, 0
    v_mov_b32 v39, 0
    v_mov_b32 v40, 0
    v_mov_b32 v41, 0
    v_mov_b32 v42, 0
    v_mov_b32 v43, 0
    v_mov_b32 v44, 0
    v_mov_b32 v45, 0
    v_mov_b32 v46, 0
    v_mov_b32 v47, 0
    v_mov_b32 v48, 0
    v_mov_b32 v49, 0
    v_mov_b32 v50, 0
    v_mov_b32 v51, 0
    v_mov_b32 v52, 0
    v_mov_b32 v53, 0
    v_mov_b32 v54, 0
    v_mov_b32 v55, 0
    v_mov_b32 v56, 0
    v_mov_b32 v57, 0
    v_mov_b32 v58, 0
    v_mov_b32 v59, 0
    v_mov_b32 v60, 0
    v_mov_b32 v61, 0
    v_mov_b32 v62, 0
    v_mov_b32 v63, 0
    s_cmp_eq_u32 s60, 0
    s_cselect_b32 s4, 4, 0
    s_lshl_b32 s4, s4, 11
    s_add_u32 s4, s4, s29
    s_cmp_eq_u32 s60, 1
    s_cselect_b32 s5, 5, 1
    s_lshl_b32 s5, s5, 11
    s_add_u32 s5, s5, s29
    s_cmp_eq_u32 s60, 2
    s_cselect_b32 s34, 6, 2
    s_lshl_b32 s34, s34, 11
    s_add_u32 s34, s34, s29
    s_cmp_eq_u32 s60, 3
    s_cselect_b32 s35, 7, 3
    s_lshl_b32 s35, s35, 11
    s_add_u32 s35, s35, s29
    s_mov_b32 s41, s36
    s_add_u32 s42, s60, 28
    s_lshl_b32 s42, s42, 11
    s_add_u32 s42, s42, s29
    s_lshl_b32 s43, s60, 11
    s_add_u32 s43, s43, s29
    v_add_u32 v190, 114688, v231
    s_lshl_b32 s30, s2, 2
    s_add_u32 s30, s30, s3
    s_xor_b32 s31, s30, 16
    s_lshl_b32 s32, s30, 6
    s_add_u32 s32, s32, 42008576
    v_mov_b32 v188, s32
    s_lshl_b32 s32, s31, 6
    s_add_u32 s32, s32, 42008576
    v_mov_b32 v189, s32
    s_lshl_b32 s30, s30, 12
    s_lshl_b32 s31, s31, 12
    s_waitcnt vmcnt(0)
    s_barrier
    s_cmp_lg_u32 s3, 0
    s_cbranch_scc1 sequential_preLN__spectral_gfnet__glu_gated_bilinear__prompt_kernel_b_skip1
    s_lshl_b32 s63, s49, 1
    s_add_u32 s63, s63, s26
    s_add_u32 s63, s63, 40
    s_lshl_b32 s63, s63, 8
    s_add_u32 s63, s63, 41943040
    v_mov_b32 v224, s63
    v_mov_b32 v225, 1
    s_mov_b64 exec, 1
    s_lshl_b32 s63, s49, 5
    s_add_u32 s63, s63, s48
    s_add_u32 s63, s63, 256
    s_lshl_b32 s63, s63, 7
    s_add_u32 s63, s63, 42074112
    v_mov_b32 v227, s63
    global_store_dword v227, v225, s[10:11] sc1
    global_atomic_add v226, v224, v225, s[10:11] sc0 sc1
    s_mov_b64 exec, -1
sequential_preLN__spectral_gfnet__glu_gated_bilinear__prompt_kernel_b_skip1:
    s_cmp_lg_u32 s3, 0
    s_cbranch_scc1 sequential_preLN__spectral_gfnet__glu_gated_bilinear__prompt_kernel_b_skip2
    s_waitcnt vmcnt(0)
    v_readfirstlane_b32 s63, v226
    s_sub_u32 s63, 13, s63
    s_cbranch_scc1 sequential_preLN__spectral_gfnet__glu_gated_bilinear__prompt_kernel_b_nb
sequential_preLN__spectral_gfnet__glu_gated_bilinear__prompt_kernel_b_bo:
    s_sleep 1
    s_sub_u32 s63, s63, 1
    s_cbranch_scc0 sequential_preLN__spectral_gfnet__glu_gated_bilinear__prompt_kernel_b_bo
sequential_preLN__spectral_gfnet__glu_gated_bilinear__prompt_kernel_b_nb:
    s_and_b32 s63, s25, 14
    s_add_u32 s63, s63, s26
    s_lshl_b32 s63, s63, 4
    s_add_u32 s63, s63, 256
    s_lshl_b32 s63, s63, 7
    s_add_u32 s63, s63, 42074112
    v_mbcnt_lo_u32_b32 v224, -1, 0
    v_lshl_add_u32 v224, v224, 7, s63
    s_mov_b32 s63, 0x40000
    s_mov_b32 exec_lo, 65535
    s_mov_b32 exec_hi, 0
sequential_preLN__spectral_gfnet__glu_gated_bilinear__prompt_kernel_b_poll:
    global_load_dword v225, v224, s[10:11] sc1
    s_waitcnt vmcnt(0)
    v_cmp_ne_u32 vcc, 1, v225
    s_sub_u32 s63, s63, 1
    s_cbranch_scc1 sequential_preLN__spectral_gfnet__glu_gated_bilinear__prompt_kernel_b_done
    s_cbranch_vccz sequential_preLN__spectral_gfnet__glu_gated_bilinear__prompt_kernel_b_done
    s_sleep 2
    s_branch sequential_preLN__spectral_gfnet__glu_gated_bilinear__prompt_kernel_b_poll
sequential_preLN__spectral_gfnet__glu_gated_bilinear__prompt_kernel_b_done:
    s_mov_b64 exec, -1
sequential_preLN__spectral_gfnet__glu_gated_bilinear__prompt_kernel_b_skip2:
    s_barrier
    buffer_load_dwordx4 v[64:67], v231, s[16:19], s4 offen offset:0 sc1
    buffer_load_dword v243, v231, s[20:23], s22 offen
    buffer_load_dwordx4 v[68:71], v190, s[16:19], s4 offen offset:0 sc1
    buffer_load_dword v243, v231, s[20:23], s22 offen
    buffer_load_dwordx4 v[72:75], v231, s[16:19], s4 offen offset:1024 sc1
    buffer_load_dword v243, v231, s[20:23], s22 offen
    buffer_load_dwordx4 v[76:79], v190, s[16:19], s4 offen offset:1024 sc1
    s_add_u32 s4, s4, 8192
    s_cmp_eq_u32 s4, s42
    s_cselect_b32 s4, s43, s4
    buffer_load_dword v243, v231, s[20:23], s22 offen
    buffer_load_dwordx4 v[80:83], v231, s[16:19], s5 offen offset:0 sc1
    s_add_u32 s63, s61, 49152
    s_mov_b32 m0, s63
    s_xor_b32 s61, s61, 0x10000
    buffer_load_dwordx4 v246, s[12:15], s62 offen offset:0 lds
    buffer_load_dwordx4 v[84:87], v190, s[16:19], s5 offen offset:0 sc1
    buffer_load_dwordx4 v247, s[12:15], s62 offen offset:1024 lds
    ds_read_b64_tr_b16 v[128:129], v180 offset:0
    ds_read_b64_tr_b16 v[130:131], v180 offset:1024
    ds_read_b64_tr_b16 v[132:133], v181 offset:0
    ds_read_b64_tr_b16 v[134:135], v181 offset:1024
    ds_read_b64_tr_b16 v[136:137], v182 offset:0
    ds_read_b64_tr_b16 v[138:139], v182 offset:1024
    ds_read_b64_tr_b16 v[140:141], v183 offset:0
    ds_read_b64_tr_b16 v[142:143], v183 offset:1024
    ds_read_b64_tr_b16 v[144:145], v184 offset:0
    ds_read_b64_tr_b16 v[146:147], v184 offset:1024
    ds_read_b64_tr_b16 v[148:149], v185 offset:0
    ds_read_b64_tr_b16 v[150:151], v185 offset:1024
    s_mov_b32 s39, 6
sequential_preLN__spectral_gfnet__glu_gated_bilinear__prompt_kernel_loop5:
    s_waitcnt vmcnt(9) lgkmcnt(8)
    v_mfma_f32_16x16x32_bf16 v[0:3], v[128:131], v[64:67], v[0:3]
    ds_read_b64_tr_b16 v[152:153], v186 offset:0
    v_mfma_f32_16x16x32_bf16 v[16:19], v[128:131], v[68:71], v[16:19]
    ds_read_b64_tr_b16 v[154:155], v186 offset:1024
    buffer_load_dwordx4 v[88:91], v231, s[16:19], s5 offen offset:1024 sc1
    v_mfma_f32_16x16x32_bf16 v[20:23], v[132:135], v[68:71], v[20:23]
    ds_read_b64_tr_b16 v[156:157], v187 offset:0
    v_mfma_f32_16x16x32_bf16 v[4:7], v[132:135], v[64:67], v[4:7]
    ds_read_b64_tr_b16 v[158:159], v187 offset:1024
    s_waitcnt lgkmcnt(8)
    v_mfma_f32_16x16x32_bf16 v[8:11], v[136:139], v[64:67], v[8:11]
    ds_read_b64_tr_b16 v[128:129], v180 offset:8192
    v_mfma_f32_16x16x32_bf16 v[24:27], v[136:139], v[68:71], v[24:27]
    ds_read_b64_tr_b16 v[130:131], v180 offset:9216
    buffer_load_dwordx4 v248, s[12:15], s62 offen offset:2048 lds
    v_mfma_f32_16x16x32_bf16 v[28:31], v[140:143], v[68:71], v[28:31]
    ds_read_b64_tr_b16 v[132:133], v181 offset:8192
    v_mfma_f32_16x16x32_bf16 v[12:15], v[140:143], v[64:67], v[12:15]
    ds_read_b64_tr_b16 v[134:135], v181 offset:9216
    s_waitcnt lgkmcnt(8)
    v_mfma_f32_16x16x32_bf16 v[32:35], v[144:147], v[64:67], v[32:35]
    ds_read_b64_tr_b16 v[136:137], v182 offset:8192
    v_mfma_f32_16x16x32_bf16 v[48:51], v[144:147], v[68:71], v[48:51]
    ds_read_b64_tr_b16 v[138:139], v182 offset:9216
    buffer_load_dwordx4 v[92:95], v190, s[16:19], s5 offen offset:1024 sc1
    s_add_u32 s5, s5, 8192
    s_cmp_eq_u32 s5, s42
    s_cselect_b32 s5, s43, s5
    v_mfma_f32_16x16x32_bf16 v[52:55], v[148:151], v[68:71], v[52:55]
    ds_read_b64_tr_b16 v[140:141], v183 offset:8192
    v_mfma_f32_16x16x32_bf16 v[36:39], v[148:151], v[64:67], v[36:39]
    ds_read_b64_tr_b16 v[142:143], v183 offset:9216
    s_waitcnt lgkmcnt(8)
    v_mfma_f32_16x16x32_bf16 v[40:43], v[152:155], v[64:67], v[40:43]
    ds_read_b64_tr_b16 v[144:145], v184 offset:8192
    v_mfma_f32_16x16x32_bf16 v[56:59], v[152:155], v[68:71], v[56:59]
    ds_read_b64_tr_b16 v[146:147], v184 offset:9216
    buffer_load_dwordx4 v249, s[12:15], s62 offen offset:3072 lds
    s_add_u32 s62, s62, 524288
    s_cmp_eq_u32 s62, s40
    s_cselect_b32 s62, s41, s62
    v_mfma_f32_16x16x32_bf16 v[60:63], v[156:159], v[68:71], v[60:63]
    ds_read_b64_tr_b16 v[148:149], v185 offset:8192
    v_mfma_f32_16x16x32_bf16 v[44:47], v[156:159], v[64:67], v[44:47]
    ds_read_b64_tr_b16 v[150:151], v185 offset:9216
    s_waitcnt vmcnt(9) lgkmcnt(8)
    v_mfma_f32_16x16x32_bf16 v[0:3], v[128:131], v[72:75], v[0:3]
    ds_read_b64_tr_b16 v[152:153], v186 offset:8192
    v_mfma_f32_16x16x32_bf16 v[16:19], v[128:131], v[76:79], v[16:19]
    ds_read_b64_tr_b16 v[154:155], v186 offset:9216
    buffer_load_dwordx4 v[96:99], v231, s[16:19], s34 offen offset:0 sc1
    v_mfma_f32_16x16x32_bf16 v[20:23], v[132:135], v[76:79], v[20:23]
    ds_read_b64_tr_b16 v[156:157], v187 offset:8192
    v_mfma_f32_16x16x32_bf16 v[4:7], v[132:135], v[72:75], v[4:7]
    ds_read_b64_tr_b16 v[158:159], v187 offset:9216
    s_waitcnt lgkmcnt(8)
    v_mfma_f32_16x16x32_bf16 v[8:11], v[136:139], v[72:75], v[8:11]
    s_waitcnt vmcnt(17)
    s_barrier
    ds_read_b64_tr_b16 v[128:129], v180 offset:16384
    v_mfma_f32_16x16x32_bf16 v[24:27], v[136:139], v[76:79], v[24:27]
    ds_read_b64_tr_b16 v[130:131], v180 offset:17408
    s_add_u32 s63, s61, 0
    s_mov_b32 m0, s63
    s_nop 0
    buffer_load_dwordx4 v246, s[12:15], s53 offen offset:0 lds
    v_mfma_f32_16x16x32_bf16 v[28:31], v[140:143], v[76:79], v[28:31]
    ds_read_b64_tr_b16 v[132:133], v181 offset:16384
    v_mfma_f32_16x16x32_bf16 v[12:15], v[140:143], v[72:75], v[12:15]
    ds_read_b64_tr_b16 v[134:135], v181 offset:17408
    s_waitcnt lgkmcnt(8)
    v_mfma_f32_16x16x32_bf16 v[32:35], v[144:147], v[72:75], v[32:35]
    ds_read_b64_tr_b16 v[136:137], v182 offset:16384
    v_mfma_f32_16x16x32_bf16 v[48:51], v[144:147], v[76:79], v[48:51]
    ds_read_b64_tr_b16 v[138:139], v182 offset:17408
    buffer_load_dwordx4 v[100:103], v190, s[16:19], s34 offen offset:0 sc1
    v_mfma_f32_16x16x32_bf16 v[52:55], v[148:151], v[76:79], v[52:55]
    ds_read_b64_tr_b16 v[140:141], v183 offset:16384
    v_mfma_f32_16x16x32_bf16 v[36:39], v[148:151], v[72:75], v[36:39]
    ds_read_b64_tr_b16 v[142:143], v183 offset:17408
    s_waitcnt lgkmcnt(8)
    v_mfma_f32_16x16x32_bf16 v[40:43], v[152:155], v[72:75], v[40:43]
    ds_read_b64_tr_b16 v[144:145], v184 offset:16384
    v_mfma_f32_16x16x32_bf16 v[56:59], v[152:155], v[76:79], v[56:59]
    ds_read_b64_tr_b16 v[146:147], v184 offset:17408
    buffer_load_dwordx4 v247, s[12:15], s53 offen offset:1024 lds
    v_mfma_f32_16x16x32_bf16 v[60:63], v[156:159], v[76:79], v[60:63]
    ds_read_b64_tr_b16 v[148:149], v185 offset:16384
    v_mfma_f32_16x16x32_bf16 v[44:47], v[156:159], v[72:75], v[44:47]
    ds_read_b64_tr_b16 v[150:151], v185 offset:17408
    s_waitcnt vmcnt(9) lgkmcnt(8)
    v_mfma_f32_16x16x32_bf16 v[0:3], v[128:131], v[80:83], v[0:3]
    ds_read_b64_tr_b16 v[152:153], v186 offset:16384
    v_mfma_f32_16x16x32_bf16 v[16:19], v[128:131], v[84:87], v[16:19]
    ds_read_b64_tr_b16 v[154:155], v186 offset:17408
    buffer_load_dwordx4 v[104:107], v231, s[16:19], s34 offen offset:1024 sc1
    v_mfma_f32_16x16x32_bf16 v[20:23], v[132:135], v[84:87], v[20:23]
    ds_read_b64_tr_b16 v[156:157], v187 offset:16384
    v_mfma_f32_16x16x32_bf16 v[4:7], v[132:135], v[80:83], v[4:7]
    ds_read_b64_tr_b16 v[158:159], v187 offset:17408
    s_waitcnt lgkmcnt(8)
    v_mfma_f32_16x16x32_bf16 v[8:11], v[136:139], v[80:83], v[8:11]
    ds_read_b64_tr_b16 v[128:129], v180 offset:24576
    v_mfma_f32_16x16x32_bf16 v[24:27], v[136:139], v[84:87], v[24:27]
    ds_read_b64_tr_b16 v[130:131], v180 offset:25600
    buffer_load_dwordx4 v248, s[12:15], s53 offen offset:2048 lds
    v_mfma_f32_16x16x32_bf16 v[28:31], v[140:143], v[84:87], v[28:31]
    ds_read_b64_tr_b16 v[132:133], v181 offset:24576
    v_mfma_f32_16x16x32_bf16 v[12:15], v[140:143], v[80:83], v[12:15]
    ds_read_b64_tr_b16 v[134:135], v181 offset:25600
    s_waitcnt lgkmcnt(8)
    v_mfma_f32_16x16x32_bf16 v[32:35], v[144:147], v[80:83], v[32:35]
    ds_read_b64_tr_b16 v[136:137], v182 offset:24576
    v_mfma_f32_16x16x32_bf16 v[48:51], v[144:147], v[84:87], v[48:51]
    ds_read_b64_tr_b16 v[138:139], v182 offset:25600
    buffer_load_dwordx4 v[108:111], v190, s[16:19], s34 offen offset:1024 sc1
    s_add_u32 s34, s34, 8192
    s_cmp_eq_u32 s34, s42
    s_cselect_b32 s34, s43, s34
    v_mfma_f32_16x16x32_bf16 v[52:55], v[148:151], v[84:87], v[52:55]
    ds_read_b64_tr_b16 v[140:141], v183 offset:24576
    v_mfma_f32_16x16x32_bf16 v[36:39], v[148:151], v[80:83], v[36:39]
    ds_read_b64_tr_b16 v[142:143], v183 offset:25600
    s_waitcnt lgkmcnt(8)
    v_mfma_f32_16x16x32_bf16 v[40:43], v[152:155], v[80:83], v[40:43]
    ds_read_b64_tr_b16 v[144:145], v184 offset:24576
    v_mfma_f32_16x16x32_bf16 v[56:59], v[152:155], v[84:87], v[56:59]
    ds_read_b64_tr_b16 v[146:147], v184 offset:25600
    buffer_load_dwordx4 v249, s[12:15], s53 offen offset:3072 lds
    s_add_u32 s53, s53, 524288
    s_cmp_eq_u32 s53, s40
    s_cselect_b32 s53, s41, s53
    v_mfma_f32_16x16x32_bf16 v[60:63], v[156:159], v[84:87], v[60:63]
    ds_read_b64_tr_b16 v[148:149], v185 offset:24576
    v_mfma_f32_16x16x32_bf16 v[44:47], v[156:159], v[80:83], v[44:47]
    ds_read_b64_tr_b16 v[150:151], v185 offset:25600
    s_waitcnt vmcnt(9) lgkmcnt(8)
    v_mfma_f32_16x16x32_bf16 v[0:3], v[128:131], v[88:91], v[0:3]
    ds_read_b64_tr_b16 v[152:153], v186 offset:24576
    v_mfma_f32_16x16x32_bf16 v[16:19], v[128:131], v[92:95], v[16:19]
    ds_read_b64_tr_b16 v[154:155], v186 offset:25600
    buffer_load_dwordx4 v[112:115], v231, s[16:19], s35 offen offset:0 sc1
    v_mfma_f32_16x16x32_bf16 v[20:23], v[132:135], v[92:95], v[20:23]
    ds_read_b64_tr_b16 v[156:157], v187 offset:24576
    v_mfma_f32_16x16x32_bf16 v[4:7], v[132:135], v[88:91], v[4:7]
    ds_read_b64_tr_b16 v[158:159], v187 offset:25600
    s_waitcnt lgkmcnt(8)
    v_mfma_f32_16x16x32_bf16 v[8:11], v[136:139], v[88:91], v[8:11]
    s_waitcnt vmcnt(17)
    s_barrier
    ds_read_b64_tr_b16 v[128:129], v180 offset:32768
    v_mfma_f32_16x16x32_bf16 v[24:27], v[136:139], v[92:95], v[24:27]
    ds_read_b64_tr_b16 v[130:131], v180 offset:33792
    s_add_u32 s63, s61, 16384
    s_mov_b32 m0, s63
    s_nop 0
    buffer_load_dwordx4 v246, s[12:15], s54 offen offset:0 lds
    v_mfma_f32_16x16x32_bf16 v[28:31], v[140:143], v[92:95], v[28:31]
    ds_read_b64_tr_b16 v[132:133], v181 offset:32768
    v_mfma_f32_16x16x32_bf16 v[12:15], v[140:143], v[88:91], v[12:15]
    ds_read_b64_tr_b16 v[134:135], v181 offset:33792
    s_waitcnt lgkmcnt(8)
    v_mfma_f32_16x16x32_bf16 v[32:35], v[144:147], v[88:91], v[32:35]
    ds_read_b64_tr_b16 v[136:137], v182 offset:32768
    v_mfma_f32_16x16x32_bf16 v[48:51], v[144:147], v[92:95], v[48:51]
    ds_read_b64_tr_b16 v[138:139], v182 offset:33792
    buffer_load_dwordx4 v[116:119], v190, s[16:19], s35 offen offset:0 sc1
    v_mfma_f32_16x16x32_bf16 v[52:55], v[148:151], v[92:95], v[52:55]
    ds_read_b64_tr_b16 v[140:141], v183 offset:32768
    v_mfma_f32_16x16x32_bf16 v[36:39], v[148:151], v[88:91], v[36:39]
    ds_read_b64_tr_b16 v[142:143], v183 offset:33792
    s_waitcnt lgkmcnt(8)
    v_mfma_f32_16x16x32_bf16 v[40:43], v[152:155], v[88:91], v[40:43]
    ds_read_b64_tr_b16 v[144:145], v184 offset:32768
    v_mfma_f32_16x16x32_bf16 v[56:59], v[152:155], v[92:95], v[56:59]
    ds_read_b64_tr_b16 v[146:147], v184 offset:33792
    buffer_load_dwordx4 v247, s[12:15], s54 offen offset:1024 lds
    v_mfma_f32_16x16x32_bf16 v[60:63], v[156:159], v[92:95], v[60:63]
    ds_read_b64_tr_b16 v[148:149], v185 offset:32768
    v_mfma_f32_16x16x32_bf16 v[44:47], v[156:159], v[88:91], v[44:47]
    ds_read_b64_tr_b16 v[150:151], v185 offset:33792
    s_waitcnt vmcnt(9) lgkmcnt(8)
    v_mfma_f32_16x16x32_bf16 v[0:3], v[128:131], v[96:99], v[0:3]
    ds_read_b64_tr_b16 v[152:153], v186 offset:32768
    v_mfma_f32_16x16x32_bf16 v[16:19], v[128:131], v[100:103], v[16:19]
    ds_read_b64_tr_b16 v[154:155], v186 offset:33792
    buffer_load_dwordx4 v[120:123], v231, s[16:19], s35 offen offset:1024 sc1
    v_mfma_f32_16x16x32_bf16 v[20:23], v[132:135], v[100:103], v[20:23]
    ds_read_b64_tr_b16 v[156:157], v187 offset:32768
    v_mfma_f32_16x16x32_bf16 v[4:7], v[132:135], v[96:99], v[4:7]
    ds_read_b64_tr_b16 v[158:159], v187 offset:33792
    s_waitcnt lgkmcnt(8)
    v_mfma_f32_16x16x32_bf16 v[8:11], v[136:139], v[96:99], v[8:11]
    ds_read_b64_tr_b16 v[128:129], v180 offset:40960
    v_mfma_f32_16x16x32_bf16 v[24:27], v[136:139], v[100:103], v[24:27]
    ds_read_b64_tr_b16 v[130:131], v180 offset:41984
    buffer_load_dwordx4 v248, s[12:15], s54 offen offset:2048 lds
    v_mfma_f32_16x16x32_bf16 v[28:31], v[140:143], v[100:103], v[28:31]
    ds_read_b64_tr_b16 v[132:133], v181 offset:40960
    v_mfma_f32_16x16x32_bf16 v[12:15], v[140:143], v[96:99], v[12:15]
    ds_read_b64_tr_b16 v[134:135], v181 offset:41984
    s_waitcnt lgkmcnt(8)
    v_mfma_f32_16x16x32_bf16 v[32:35], v[144:147], v[96:99], v[32:35]
    ds_read_b64_tr_b16 v[136:137], v182 offset:40960
    v_mfma_f32_16x16x32_bf16 v[48:51], v[144:147], v[100:103], v[48:51]
    ds_read_b64_tr_b16 v[138:139], v182 offset:41984
    buffer_load_dwordx4 v[124:127], v190, s[16:19], s35 offen offset:1024 sc1
    s_add_u32 s35, s35, 8192
    s_cmp_eq_u32 s35, s42
    s_cselect_b32 s35, s43, s35
    v_mfma_f32_16x16x32_bf16 v[52:55], v[148:151], v[100:103], v[52:55]
    ds_read_b64_tr_b16 v[140:141], v183 offset:40960
    v_mfma_f32_16x16x32_bf16 v[36:39], v[148:151], v[96:99], v[36:39]
    ds_read_b64_tr_b16 v[142:143], v183 offset:41984
    s_waitcnt lgkmcnt(8)
    v_mfma_f32_16x16x32_bf16 v[40:43], v[152:155], v[96:99], v[40:43]
    ds_read_b64_tr_b16 v[144:145], v184 offset:40960
    v_mfma_f32_16x16x32_bf16 v[56:59], v[152:155], v[100:103], v[56:59]
    ds_read_b64_tr_b16 v[146:147], v184 offset:41984
    buffer_load_dwordx4 v249, s[12:15], s54 offen offset:3072 lds
    s_add_u32 s54, s54, 524288
    s_cmp_eq_u32 s54, s40
    s_cselect_b32 s54, s41, s54
    v_mfma_f32_16x16x32_bf16 v[60:63], v[156:159], v[100:103], v[60:63]
    ds_read_b64_tr_b16 v[148:149], v185 offset:40960
    v_mfma_f32_16x16x32_bf16 v[44:47], v[156:159], v[96:99], v[44:47]
    ds_read_b64_tr_b16 v[150:151], v185 offset:41984
    s_waitcnt vmcnt(9) lgkmcnt(8)
    v_mfma_f32_16x16x32_bf16 v[0:3], v[128:131], v[104:107], v[0:3]
    ds_read_b64_tr_b16 v[152:153], v186 offset:40960
    v_mfma_f32_16x16x32_bf16 v[16:19], v[128:131], v[108:111], v[16:19]
    ds_read_b64_tr_b16 v[154:155], v186 offset:41984
    buffer_load_dwordx4 v[64:67], v231, s[16:19], s4 offen offset:0 sc1
    v_mfma_f32_16x16x32_bf16 v[20:23], v[132:135], v[108:111], v[20:23]
    ds_read_b64_tr_b16 v[156:157], v187 offset:40960
    v_mfma_f32_16x16x32_bf16 v[4:7], v[132:135], v[104:107], v[4:7]
    ds_read_b64_tr_b16 v[158:159], v187 offset:41984
    s_waitcnt lgkmcnt(8)
    v_mfma_f32_16x16x32_bf16 v[8:11], v[136:139], v[104:107], v[8:11]
    s_waitcnt vmcnt(17)
    s_barrier
    ds_read_b64_tr_b16 v[128:129], v180 offset:49152
    v_mfma_f32_16x16x32_bf16 v[24:27], v[136:139], v[108:111], v[24:27]
    ds_read_b64_tr_b16 v[130:131], v180 offset:50176
    s_add_u32 s63, s61, 32768
    s_mov_b32 m0, s63
    s_nop 0
    buffer_load_dwordx4 v246, s[12:15], s55 offen offset:0 lds
    v_mfma_f32_16x16x32_bf16 v[28:31], v[140:143], v[108:111], v[28:31]
    ds_read_b64_tr_b16 v[132:133], v181 offset:49152
    v_mfma_f32_16x16x32_bf16 v[12:15], v[140:143], v[104:107], v[12:15]
    ds_read_b64_tr_b16 v[134:135], v181 offset:50176
    s_waitcnt lgkmcnt(8)
    v_mfma_f32_16x16x32_bf16 v[32:35], v[144:147], v[104:107], v[32:35]
    ds_read_b64_tr_b16 v[136:137], v182 offset:49152
    v_mfma_f32_16x16x32_bf16 v[48:51], v[144:147], v[108:111], v[48:51]
    ds_read_b64_tr_b16 v[138:139], v182 offset:50176
    buffer_load_dwordx4 v[68:71], v190, s[16:19], s4 offen offset:0 sc1
    v_mfma_f32_16x16x32_bf16 v[52:55], v[148:151], v[108:111], v[52:55]
    ds_read_b64_tr_b16 v[140:141], v183 offset:49152
    v_mfma_f32_16x16x32_bf16 v[36:39], v[148:151], v[104:107], v[36:39]
    ds_read_b64_tr_b16 v[142:143], v183 offset:50176
    s_waitcnt lgkmcnt(8)
    v_mfma_f32_16x16x32_bf16 v[40:43], v[152:155], v[104:107], v[40:43]
    ds_read_b64_tr_b16 v[144:145], v184 offset:49152
    v_mfma_f32_16x16x32_bf16 v[56:59], v[152:155], v[108:111], v[56:59]
    ds_read_b64_tr_b16 v[146:147], v184 offset:50176
    buffer_load_dwordx4 v247, s[12:15], s55 offen offset:1024 lds
    v_mfma_f32_16x16x32_bf16 v[60:63], v[156:159], v[108:111], v[60:63]
    ds_read_b64_tr_b16 v[148:149], v185 offset:49152
    v_mfma_f32_16x16x32_bf16 v[44:47], v[156:159], v[104:107], v[44:47]
    ds_read_b64_tr_b16 v[150:151], v185 offset:50176
    s_waitcnt vmcnt(9) lgkmcnt(8)
    v_mfma_f32_16x16x32_bf16 v[0:3], v[128:131], v[112:115], v[0:3]
    ds_read_b64_tr_b16 v[152:153], v186 offset:49152
    v_mfma_f32_16x16x32_bf16 v[16:19], v[128:131], v[116:119], v[16:19]
    ds_read_b64_tr_b16 v[154:155], v186 offset:50176
    buffer_load_dwordx4 v[72:75], v231, s[16:19], s4 offen offset:1024 sc1
    v_mfma_f32_16x16x32_bf16 v[20:23], v[132:135], v[116:119], v[20:23]
    ds_read_b64_tr_b16 v[156:157], v187 offset:49152
    v_mfma_f32_16x16x32_bf16 v[4:7], v[132:135], v[112:115], v[4:7]
    ds_read_b64_tr_b16 v[158:159], v187 offset:50176
    s_waitcnt lgkmcnt(8)
    v_mfma_f32_16x16x32_bf16 v[8:11], v[136:139], v[112:115], v[8:11]
    ds_read_b64_tr_b16 v[128:129], v180 offset:57344
    v_mfma_f32_16x16x32_bf16 v[24:27], v[136:139], v[116:119], v[24:27]
    ds_read_b64_tr_b16 v[130:131], v180 offset:58368
    buffer_load_dwordx4 v248, s[12:15], s55 offen offset:2048 lds
    v_mfma_f32_16x16x32_bf16 v[28:31], v[140:143], v[116:119], v[28:31]
    ds_read_b64_tr_b16 v[132:133], v181 offset:57344
    v_mfma_f32_16x16x32_bf16 v[12:15], v[140:143], v[112:115], v[12:15]
    ds_read_b64_tr_b16 v[134:135], v181 offset:58368
    s_waitcnt lgkmcnt(8)
    v_mfma_f32_16x16x32_bf16 v[32:35], v[144:147], v[112:115], v[32:35]
    ds_read_b64_tr_b16 v[136:137], v182 offset:57344
    v_mfma_f32_16x16x32_bf16 v[48:51], v[144:147], v[116:119], v[48:51]
    ds_read_b64_tr_b16 v[138:139], v182 offset:58368
    buffer_load_dwordx4 v[76:79], v190, s[16:19], s4 offen offset:1024 sc1
    s_add_u32 s4, s4, 8192
    s_cmp_eq_u32 s4, s42
    s_cselect_b32 s4, s43, s4
    v_mfma_f32_16x16x32_bf16 v[52:55], v[148:151], v[116:119], v[52:55]
    ds_read_b64_tr_b16 v[140:141], v183 offset:57344
    v_mfma_f32_16x16x32_bf16 v[36:39], v[148:151], v[112:115], v[36:39]
    ds_read_b64_tr_b16 v[142:143], v183 offset:58368
    s_waitcnt lgkmcnt(8)
    v_mfma_f32_16x16x32_bf16 v[40:43], v[152:155], v[112:115], v[40:43]
    ds_read_b64_tr_b16 v[144:145], v184 offset:57344
    v_mfma_f32_16x16x32_bf16 v[56:59], v[152:155], v[116:119], v[56:59]
    ds_read_b64_tr_b16 v[146:147], v184 offset:58368
    buffer_load_dwordx4 v249, s[12:15], s55 offen offset:3072 lds
    s_add_u32 s55, s55, 524288
    s_cmp_eq_u32 s55, s40
    s_cselect_b32 s55, s41, s55
    v_mfma_f32_16x16x32_bf16 v[60:63], v[156:159], v[116:119], v[60:63]
    ds_read_b64_tr_b16 v[148:149], v185 offset:57344
    v_mfma_f32_16x16x32_bf16 v[44:47], v[156:159], v[112:115], v[44:47]
    ds_read_b64_tr_b16 v[150:151], v185 offset:58368
    s_waitcnt vmcnt(9) lgkmcnt(8)
    v_mfma_f32_16x16x32_bf16 v[0:3], v[128:131], v[120:123], v[0:3]
    ds_read_b64_tr_b16 v[152:153], v186 offset:57344
    v_mfma_f32_16x16x32_bf16 v[16:19], v[128:131], v[124:127], v[16:19]
    ds_read_b64_tr_b16 v[154:155], v186 offset:58368
    buffer_load_dwordx4 v[80:83], v231, s[16:19], s5 offen offset:0 sc1
    v_mfma_f32_16x16x32_bf16 v[20:23], v[132:135], v[124:127], v[20:23]
    ds_read_b64_tr_b16 v[156:157], v187 offset:57344
    v_mfma_f32_16x16x32_bf16 v[4:7], v[132:135], v[120:123], v[4:7]
    ds_read_b64_tr_b16 v[158:159], v187 offset:58368
    s_waitcnt lgkmcnt(8)
    v_mfma_f32_16x16x32_bf16 v[8:11], v[136:139], v[120:123], v[8:11]
    s_waitcnt vmcnt(17)
    s_barrier
    v_xor_b32 v180, 0x10000, v180
    v_xor_b32 v181, 0x10000, v181
    v_xor_b32 v182, 0x10000, v182
    v_xor_b32 v183, 0x10000, v183
    v_xor_b32 v184, 0x10000, v184
    v_xor_b32 v185, 0x10000, v185
    v_xor_b32 v186, 0x10000, v186
    v_xor_b32 v187, 0x10000, v187
    ds_read_b64_tr_b16 v[128:129], v180 offset:0
    v_mfma_f32_16x16x32_bf16 v[24:27], v[136:139], v[124:127], v[24:27]
    ds_read_b64_tr_b16 v[130:131], v180 offset:1024
    s_add_u32 s63, s61, 49152
    s_mov_b32 m0, s63
    s_xor_b32 s61, s61, 0x10000
    buffer_load_dwordx4 v246, s[12:15], s62 offen offset:0 lds
    v_mfma_f32_16x16x32_bf16 v[28:31], v[140:143], v[124:127], v[28:31]
    ds_read_b64_tr_b16 v[132:133], v181 offset:0
    v_mfma_f32_16x16x32_bf16 v[12:15], v[140:143], v[120:123], v[12:15]
    ds_read_b64_tr_b16 v[134:135], v181 offset:1024
    s_waitcnt lgkmcnt(8)
    v_mfma_f32_16x16x32_bf16 v[32:35], v[144:147], v[120:123], v[32:35]
    ds_read_b64_tr_b16 v[136:137], v182 offset:0
    v_mfma_f32_16x16x32_bf16 v[48:51], v[144:147], v[124:127], v[48:51]
    ds_read_b64_tr_b16 v[138:139], v182 offset:1024
    buffer_load_dwordx4 v[84:87], v190, s[16:19], s5 offen offset:0 sc1
    v_mfma_f32_16x16x32_bf16 v[52:55], v[148:151], v[124:127], v[52:55]
    ds_read_b64_tr_b16 v[140:141], v183 offset:0
    v_mfma_f32_16x16x32_bf16 v[36:39], v[148:151], v[120:123], v[36:39]
    ds_read_b64_tr_b16 v[142:143], v183 offset:1024
    s_waitcnt lgkmcnt(8)
    v_mfma_f32_16x16x32_bf16 v[40:43], v[152:155], v[120:123], v[40:43]
    ds_read_b64_tr_b16 v[144:145], v184 offset:0
    v_mfma_f32_16x16x32_bf16 v[56:59], v[152:155], v[124:127], v[56:59]
    ds_read_b64_tr_b16 v[146:147], v184 offset:1024
    buffer_load_dwordx4 v247, s[12:15], s62 offen offset:1024 lds
    v_mfma_f32_16x16x32_bf16 v[60:63], v[156:159], v[124:127], v[60:63]
    ds_read_b64_tr_b16 v[148:149], v185 offset:0
    v_mfma_f32_16x16x32_bf16 v[44:47], v[156:159], v[120:123], v[44:47]
    ds_read_b64_tr_b16 v[150:151], v185 offset:1024
    s_sub_u32 s39, s39, 1
    s_cmp_lg_u32 s39, 0
    s_cbranch_scc1 sequential_preLN__spectral_gfnet__glu_gated_bilinear__prompt_kernel_loop5
    s_waitcnt vmcnt(9) lgkmcnt(8)
    v_mfma_f32_16x16x32_bf16 v[0:3], v[128:131], v[64:67], v[0:3]
    ds_read_b64_tr_b16 v[152:153], v186 offset:0
    v_mfma_f32_16x16x32_bf16 v[16:19], v[128:131], v[68:71], v[16:19]
    ds_read_b64_tr_b16 v[154:155], v186 offset:1024
    buffer_load_dwordx4 v[88:91], v231, s[16:19], s5 offen offset:1024 sc1
    v_mfma_f32_16x16x32_bf16 v[20:23], v[132:135], v[68:71], v[20:23]
    ds_read_b64_tr_b16 v[156:157], v187 offset:0
    v_mfma_f32_16x16x32_bf16 v[4:7], v[132:135], v[64:67], v[4:7]
    ds_read_b64_tr_b16 v[158:159], v187 offset:1024
    buffer_load_dwordx4 v248, s[12:15], s62 offen offset:2048 lds
    s_waitcnt lgkmcnt(8)
    v_mfma_f32_16x16x32_bf16 v[8:11], v[136:139], v[64:67], v[8:11]
    ds_read_b64_tr_b16 v[128:129], v184 offset:8192
    v_mfma_f32_16x16x32_bf16 v[24:27], v[136:139], v[68:71], v[24:27]
    ds_read_b64_tr_b16 v[130:131], v184 offset:9216
    buffer_load_dwordx4 v[92:95], v190, s[16:19], s5 offen offset:1024 sc1
    s_add_u32 s5, s5, 8192
    s_cmp_eq_u32 s5, s42
    s_cselect_b32 s5, s43, s5
    v_mfma_f32_16x16x32_bf16 v[28:31], v[140:143], v[68:71], v[28:31]
    ds_read_b64_tr_b16 v[132:133], v185 offset:8192
    v_mfma_f32_16x16x32_bf16 v[12:15], v[140:143], v[64:67], v[12:15]
    ds_read_b64_tr_b16 v[134:135], v185 offset:9216
    buffer_load_dwordx4 v249, s[12:15], s62 offen offset:3072 lds
    s_add_u32 s62, s62, 524288
    s_cmp_eq_u32 s62, s40
    s_cselect_b32 s62, s41, s62
    s_waitcnt lgkmcnt(8)
    v_mfma_f32_16x16x32_bf16 v[32:35], v[144:147], v[64:67], v[32:35]
    ds_read_b64_tr_b16 v[136:137], v186 offset:8192
    v_mfma_f32_16x16x32_bf16 v[48:51], v[144:147], v[68:71], v[48:51]
    ds_read_b64_tr_b16 v[138:139], v186 offset:9216
    buffer_load_dwordx4 v[96:99], v231, s[16:19], s34 offen offset:0 sc1
    v_mfma_f32_16x16x32_bf16 v[52:55], v[148:151], v[68:71], v[52:55]
    ds_read_b64_tr_b16 v[140:141], v187 offset:8192
    v_mfma_f32_16x16x32_bf16 v[36:39], v[148:151], v[64:67], v[36:39]
    ds_read_b64_tr_b16 v[142:143], v187 offset:9216
    buffer_load_dwordx4 v[100:103], v190, s[16:19], s34 offen offset:0 sc1
    s_waitcnt lgkmcnt(8)
    v_mfma_f32_16x16x32_bf16 v[40:43], v[152:155], v[64:67], v[40:43]
    s_waitcnt vmcnt(18)
    s_barrier
    ds_read_b64_tr_b16 v[144:145], v184 offset:16384
    v_mfma_f32_16x16x32_bf16 v[56:59], v[152:155], v[68:71], v[56:59]
    ds_read_b64_tr_b16 v[146:147], v184 offset:17408
    buffer_load_dwordx4 v[104:107], v231, s[16:19], s34 offen offset:1024 sc1
    v_mfma_f32_16x16x32_bf16 v[60:63], v[156:159], v[68:71], v[60:63]
    ds_read_b64_tr_b16 v[148:149], v185 offset:16384
    v_mfma_f32_16x16x32_bf16 v[44:47], v[156:159], v[64:67], v[44:47]
    ds_read_b64_tr_b16 v[150:151], v185 offset:17408
    buffer_load_dwordx4 v[108:111], v190, s[16:19], s34 offen offset:1024 sc1
    s_add_u32 s34, s34, 8192
    s_cmp_eq_u32 s34, s42
    s_cselect_b32 s34, s43, s34
    s_waitcnt vmcnt(13) lgkmcnt(8)
    v_mfma_f32_16x16x32_bf16 v[32:35], v[128:131], v[72:75], v[32:35]
    ds_read_b64_tr_b16 v[152:153], v186 offset:16384
    v_mfma_f32_16x16x32_bf16 v[48:51], v[128:131], v[76:79], v[48:51]
    ds_read_b64_tr_b16 v[154:155], v186 offset:17408
    buffer_load_dwordx4 v[112:115], v231, s[16:19], s35 offen offset:0 sc1
    v_mfma_f32_16x16x32_bf16 v[52:55], v[132:135], v[76:79], v[52:55]
    ds_read_b64_tr_b16 v[156:157], v187 offset:16384
    v_mfma_f32_16x16x32_bf16 v[36:39], v[132:135], v[72:75], v[36:39]
    ds_read_b64_tr_b16 v[158:159], v187 offset:17408
    buffer_load_dwordx4 v[116:119], v190, s[16:19], s35 offen offset:0 sc1
    s_waitcnt lgkmcnt(8)
    v_mfma_f32_16x16x32_bf16 v[40:43], v[136:139], v[72:75], v[40:43]
    ds_read_b64_tr_b16 v[128:129], v184 offset:24576
    v_mfma_f32_16x16x32_bf16 v[56:59], v[136:139], v[76:79], v[56:59]
    ds_read_b64_tr_b16 v[130:131], v184 offset:25600
    buffer_load_dwordx4 v[120:123], v231, s[16:19], s35 offen offset:1024 sc1
    v_mfma_f32_16x16x32_bf16 v[60:63], v[140:143], v[76:79], v[60:63]
    ds_read_b64_tr_b16 v[132:133], v185 offset:24576
    v_mfma_f32_16x16x32_bf16 v[44:47], v[140:143], v[72:75], v[44:47]
    ds_read_b64_tr_b16 v[134:135], v185 offset:25600
    buffer_load_dwordx4 v[124:127], v190, s[16:19], s35 offen offset:1024 sc1
    s_add_u32 s35, s35, 8192
    s_cmp_eq_u32 s35, s42
    s_cselect_b32 s35, s43, s35
    s_waitcnt vmcnt(13) lgkmcnt(8)
    v_mfma_f32_16x16x32_bf16 v[32:35], v[144:147], v[80:83], v[32:35]
    ds_read_b64_tr_b16 v[136:137], v186 offset:24576
    v_mfma_f32_16x16x32_bf16 v[48:51], v[144:147], v[84:87], v[48:51]
    ds_read_b64_tr_b16 v[138:139], v186 offset:25600
    buffer_load_dwordx4 v[160:163], v231, s[44:47], s33 offen offset:0 sc1
    v_mfma_f32_16x16x32_bf16 v[52:55], v[148:151], v[84:87], v[52:55]
    ds_read_b64_tr_b16 v[140:141], v187 offset:24576
    v_mfma_f32_16x16x32_bf16 v[36:39], v[148:151], v[80:83], v[36:39]
    ds_read_b64_tr_b16 v[142:143], v187 offset:25600
    buffer_load_dwordx4 v[164:167], v231, s[44:47], s33 offen offset:1024 sc1
    s_waitcnt lgkmcnt(8)
    v_mfma_f32_16x16x32_bf16 v[40:43], v[152:155], v[80:83], v[40:43]
    s_waitcnt vmcnt(18)
    s_barrier
    ds_read_b64_tr_b16 v[144:145], v184 offset:32768
    v_mfma_f32_16x16x32_bf16 v[56:59], v[152:155], v[84:87], v[56:59]
    ds_read_b64_tr_b16 v[146:147], v184 offset:33792
    buffer_load_dwordx4 v[168:171], v231, s[44:47], s37 offen offset:0 sc1
    v_mfma_f32_16x16x32_bf16 v[60:63], v[156:159], v[84:87], v[60:63]
    ds_read_b64_tr_b16 v[148:149], v185 offset:32768
    v_mfma_f32_16x16x32_bf16 v[44:47], v[156:159], v[80:83], v[44:47]
    ds_read_b64_tr_b16 v[150:151], v185 offset:33792
    buffer_load_dwordx4 v[172:175], v231, s[44:47], s37 offen offset:1024 sc1
    s_waitcnt vmcnt(13) lgkmcnt(8)
    v_mfma_f32_16x16x32_bf16 v[32:35], v[128:131], v[88:91], v[32:35]
    ds_read_b64_tr_b16 v[152:153], v186 offset:32768
    v_mfma_f32_16x16x32_bf16 v[48:51], v[128:131], v[92:95], v[48:51]
    ds_read_b64_tr_b16 v[154:155], v186 offset:33792
    global_load_dwordx2 v[192:193], v178, s[10:11] offset:0 sc1
    v_mfma_f32_16x16x32_bf16 v[52:55], v[132:135], v[92:95], v[52:55]
    ds_read_b64_tr_b16 v[156:157], v187 offset:32768
    v_mfma_f32_16x16x32_bf16 v[36:39], v[132:135], v[88:91], v[36:39]
    ds_read_b64_tr_b16 v[158:159], v187 offset:33792
    global_load_dwordx2 v[194:195], v178, s[10:11] offset:128 sc1
    s_waitcnt lgkmcnt(8)
    v_mfma_f32_16x16x32_bf16 v[40:43], v[136:139], v[88:91], v[40:43]
    ds_read_b64_tr_b16 v[128:129], v184 offset:40960
    v_mfma_f32_16x16x32_bf16 v[56:59], v[136:139], v[92:95], v[56:59]
    ds_read_b64_tr_b16 v[130:131], v184 offset:41984
    v_mfma_f32_16x16x32_bf16 v[60:63], v[140:143], v[92:95], v[60:63]
    ds_read_b64_tr_b16 v[132:133], v185 offset:40960
    v_mfma_f32_16x16x32_bf16 v[44:47], v[140:143], v[88:91], v[44:47]
    ds_read_b64_tr_b16 v[134:135], v185 offset:41984
    s_waitcnt vmcnt(12) lgkmcnt(8)
    v_mfma_f32_16x16x32_bf16 v[32:35], v[144:147], v[96:99], v[32:35]
    ds_read_b64_tr_b16 v[136:137], v186 offset:40960
    v_mfma_f32_16x16x32_bf16 v[48:51], v[144:147], v[100:103], v[48:51]
    ds_read_b64_tr_b16 v[138:139], v186 offset:41984
    v_mfma_f32_16x16x32_bf16 v[52:55], v[148:151], v[100:103], v[52:55]
    ds_read_b64_tr_b16 v[140:141], v187 offset:40960
    v_mfma_f32_16x16x32_bf16 v[36:39], v[148:151], v[96:99], v[36:39]
    ds_read_b64_tr_b16 v[142:143], v187 offset:41984
    s_waitcnt lgkmcnt(8)
    v_mfma_f32_16x16x32_bf16 v[40:43], v[152:155], v[96:99], v[40:43]
    s_waitcnt vmcnt(14)
    s_barrier
    ds_read_b64_tr_b16 v[144:145], v184 offset:49152
    v_mfma_f32_16x16x32_bf16 v[56:59], v[152:155], v[100:103], v[56:59]
    ds_read_b64_tr_b16 v[146:147], v184 offset:50176
    v_mfma_f32_16x16x32_bf16 v[60:63], v[156:159], v[100:103], v[60:63]
    ds_read_b64_tr_b16 v[148:149], v185 offset:49152
    v_mfma_f32_16x16x32_bf16 v[44:47], v[156:159], v[96:99], v[44:47]
    ds_read_b64_tr_b16 v[150:151], v185 offset:50176
    s_waitcnt vmcnt(10) lgkmcnt(8)
    v_mfma_f32_16x16x32_bf16 v[32:35], v[128:131], v[104:107], v[32:35]
    ds_read_b64_tr_b16 v[152:153], v186 offset:49152
    v_mfma_f32_16x16x32_bf16 v[48:51], v[128:131], v[108:111], v[48:51]
    ds_read_b64_tr_b16 v[154:155], v186 offset:50176
    v_mfma_f32_16x16x32_bf16 v[52:55], v[132:135], v[108:111], v[52:55]
    ds_read_b64_tr_b16 v[156:157], v187 offset:49152
    v_mfma_f32_16x16x32_bf16 v[36:39], v[132:135], v[104:107], v[36:39]
    ds_read_b64_tr_b16 v[158:159], v187 offset:50176
    s_waitcnt lgkmcnt(8)
    v_mfma_f32_16x16x32_bf16 v[40:43], v[136:139], v[104:107], v[40:43]
    ds_read_b64_tr_b16 v[128:129], v184 offset:57344
    v_mfma_f32_16x16x32_bf16 v[56:59], v[136:139], v[108:111], v[56:59]
    ds_read_b64_tr_b16 v[130:131], v184 offset:58368
    v_mfma_f32_16x16x32_bf16 v[60:63], v[140:143], v[108:111], v[60:63]
    ds_read_b64_tr_b16 v[132:133], v185 offset:57344
    v_mfma_f32_16x16x32_bf16 v[44:47], v[140:143], v[104:107], v[44:47]
    ds_read_b64_tr_b16 v[134:135], v185 offset:58368
    s_waitcnt vmcnt(8) lgkmcnt(8)
    v_mfma_f32_16x16x32_bf16 v[32:35], v[144:147], v[112:115], v[32:35]
    ds_read_b64_tr_b16 v[136:137], v186 offset:57344
    v_mfma_f32_16x16x32_bf16 v[48:51], v[144:147], v[116:119], v[48:51]
    ds_read_b64_tr_b16 v[138:139], v186 offset:58368
    v_mfma_f32_16x16x32_bf16 v[52:55], v[148:151], v[116:119], v[52:55]
    ds_read_b64_tr_b16 v[140:141], v187 offset:57344
    v_mfma_f32_16x16x32_bf16 v[36:39], v[148:151], v[112:115], v[36:39]
    ds_read_b64_tr_b16 v[142:143], v187 offset:58368
    s_waitcnt lgkmcnt(8)
    v_mfma_f32_16x16x32_bf16 v[40:43], v[152:155], v[112:115], v[40:43]
    ds_read_b64_tr_b16 v[144:145], v180 offset:8192
    v_mfma_f32_16x16x32_bf16 v[56:59], v[152:155], v[116:119], v[56:59]
    ds_read_b64_tr_b16 v[146:147], v180 offset:9216
    v_mfma_f32_16x16x32_bf16 v[60:63], v[156:159], v[116:119], v[60:63]
    ds_read_b64_tr_b16 v[148:149], v181 offset:8192
    v_mfma_f32_16x16x32_bf16 v[44:47], v[156:159], v[112:115], v[44:47]
    ds_read_b64_tr_b16 v[150:151], v181 offset:9216
    s_waitcnt vmcnt(6) lgkmcnt(8)
    v_mfma_f32_16x16x32_bf16 v[32:35], v[128:131], v[120:123], v[32:35]
    ds_read_b64_tr_b16 v[152:153], v182 offset:8192
    v_mfma_f32_16x16x32_bf16 v[48:51], v[128:131], v[124:127], v[48:51]
    ds_read_b64_tr_b16 v[154:155], v182 offset:9216
    v_mfma_f32_16x16x32_bf16 v[52:55], v[132:135], v[124:127], v[52:55]
    ds_read_b64_tr_b16 v[156:157], v183 offset:8192
    v_mfma_f32_16x16x32_bf16 v[36:39], v[132:135], v[120:123], v[36:39]
    ds_read_b64_tr_b16 v[158:159], v183 offset:9216
    s_waitcnt lgkmcnt(8)
    v_mfma_f32_16x16x32_bf16 v[40:43], v[136:139], v[120:123], v[40:43]
    ds_read_b64_tr_b16 v[128:129], v180 offset:16384
    v_mfma_f32_16x16x32_bf16 v[56:59], v[136:139], v[124:127], v[56:59]
    ds_read_b64_tr_b16 v[130:131], v180 offset:17408
    v_mfma_f32_16x16x32_bf16 v[60:63], v[140:143], v[124:127], v[60:63]
    ds_read_b64_tr_b16 v[132:133], v181 offset:16384
    v_mfma_f32_16x16x32_bf16 v[44:47], v[140:143], v[120:123], v[44:47]
    ds_read_b64_tr_b16 v[134:135], v181 offset:17408
    s_waitcnt lgkmcnt(8)
    v_mfma_f32_16x16x32_bf16 v[0:3], v[144:147], v[72:75], v[0:3]
    ds_read_b64_tr_b16 v[136:137], v182 offset:16384
    v_mfma_f32_16x16x32_bf16 v[16:19], v[144:147], v[76:79], v[16:19]
    ds_read_b64_tr_b16 v[138:139], v182 offset:17408
    s_add_u32 s16, s10, 52428800
    v_mfma_f32_16x16x32_bf16 v[20:23], v[148:151], v[76:79], v[20:23]
    ds_read_b64_tr_b16 v[140:141], v183 offset:16384
    s_addc_u32 s17, s11, 0
    s_mov_b32 s18, 4194304
    s_mov_b32 s12, s58
    s_mov_b32 s13, s59
    v_mfma_f32_16x16x32_bf16 v[4:7], v[148:151], v[72:75], v[4:7]
    ds_read_b64_tr_b16 v[142:143], v183 offset:17408
    s_mov_b32 s14, 4194304
    v_permlane16_swap_b32 v32, v36
    v_permlane16_swap_b32 v33, v37
    v_permlane16_swap_b32 v34, v38
    s_waitcnt lgkmcnt(8)
    v_mfma_f32_16x16x32_bf16 v[8:11], v[152:155], v[72:75], v[8:11]
    ds_read_b64_tr_b16 v[144:145], v180 offset:24576
    v_permlane16_swap_b32 v35, v39
    v_cvt_pk_bf16_f32 v32, v32, v33
    v_cvt_pk_bf16_f32 v33, v34, v35
    v_cvt_pk_bf16_f32 v34, v36, v37
    v_mfma_f32_16x16x32_bf16 v[24:27], v[152:155], v[76:79], v[24:27]
    ds_read_b64_tr_b16 v[146:147], v180 offset:25600
    v_cvt_pk_bf16_f32 v35, v38, v39
    buffer_store_dwordx4 v[32:35], v231, s[16:19], s30 offen offset:0 sc1
    v_permlane16_swap_b32 v40, v44
    v_permlane16_swap_b32 v41, v45
    v_mfma_f32_16x16x32_bf16 v[28:31], v[156:159], v[76:79], v[28:31]
    ds_read_b64_tr_b16 v[148:149], v181 offset:24576
    v_permlane16_swap_b32 v42, v46
    v_permlane16_swap_b32 v43, v47
    v_cvt_pk_bf16_f32 v40, v40, v41
    v_cvt_pk_bf16_f32 v41, v42, v43
    v_mfma_f32_16x16x32_bf16 v[12:15], v[156:159], v[72:75], v[12:15]
    ds_read_b64_tr_b16 v[150:151], v181 offset:25600
    v_cvt_pk_bf16_f32 v42, v44, v45
    v_cvt_pk_bf16_f32 v43, v46, v47
    buffer_store_dwordx4 v[40:43], v231, s[16:19], s30 offen offset:1024 sc1
    v_permlane16_swap_b32 v48, v52
    s_waitcnt lgkmcnt(8)
    v_mfma_f32_16x16x32_bf16 v[0:3], v[128:131], v[80:83], v[0:3]
    ds_read_b64_tr_b16 v[152:153], v182 offset:24576
    v_permlane16_swap_b32 v49, v53
    v_permlane16_swap_b32 v50, v54
    v_permlane16_swap_b32 v51, v55
    v_cvt_pk_bf16_f32 v48, v48, v49
    v_mfma_f32_16x16x32_bf16 v[16:19], v[128:131], v[84:87], v[16:19]
    ds_read_b64_tr_b16 v[154:155], v182 offset:25600
    v_cvt_pk_bf16_f32 v49, v50, v51
    v_cvt_pk_bf16_f32 v50, v52, v53
    v_cvt_pk_bf16_f32 v51, v54, v55
    buffer_store_dwordx4 v[48:51], v231, s[16:19], s30 offen offset:2048 sc1
    v_mfma_f32_16x16x32_bf16 v[20:23], v[132:135], v[84:87], v[20:23]
    ds_read_b64_tr_b16 v[156:157], v183 offset:24576
    v_permlane16_swap_b32 v56, v60
    v_permlane16_swap_b32 v57, v61
    v_permlane16_swap_b32 v58, v62
    v_permlane16_swap_b32 v59, v63
    v_mfma_f32_16x16x32_bf16 v[4:7], v[132:135], v[80:83], v[4:7]
    ds_read_b64_tr_b16 v[158:159], v183 offset:25600
    v_cvt_pk_bf16_f32 v56, v56, v57
    v_cvt_pk_bf16_f32 v57, v58, v59
    v_cvt_pk_bf16_f32 v58, v60, v61
    v_cvt_pk_bf16_f32 v59, v62, v63
    s_waitcnt lgkmcnt(8)
    v_mfma_f32_16x16x32_bf16 v[8:11], v[136:139], v[80:83], v[8:11]
    ds_read_b64_tr_b16 v[128:129], v180 offset:32768
    buffer_store_dwordx4 v[56:59], v231, s[16:19], s30 offen offset:3072 sc1
    v_mfma_f32_16x16x32_bf16 v[24:27], v[136:139], v[84:87], v[24:27]
    ds_read_b64_tr_b16 v[130:131], v180 offset:33792
    v_mfma_f32_16x16x32_bf16 v[28:31], v[140:143], v[84:87], v[28:31]
    ds_read_b64_tr_b16 v[132:133], v181 offset:32768
    v_mfma_f32_16x16x32_bf16 v[12:15], v[140:143], v[80:83], v[12:15]
    ds_read_b64_tr_b16 v[134:135], v181 offset:33792
    s_waitcnt lgkmcnt(8)
    v_mfma_f32_16x16x32_bf16 v[0:3], v[144:147], v[88:91], v[0:3]
    ds_read_b64_tr_b16 v[136:137], v182 offset:32768
    v_mfma_f32_16x16x32_bf16 v[16:19], v[144:147], v[92:95], v[16:19]
    ds_read_b64_tr_b16 v[138:139], v182 offset:33792
    v_mfma_f32_16x16x32_bf16 v[20:23], v[148:151], v[92:95], v[20:23]
    ds_read_b64_tr_b16 v[140:141], v183 offset:32768
    v_mfma_f32_16x16x32_bf16 v[4:7], v[148:151], v[88:91], v[4:7]
    ds_read_b64_tr_b16 v[142:143], v183 offset:33792
    s_waitcnt lgkmcnt(8)
    v_mfma_f32_16x16x32_bf16 v[8:11], v[152:155], v[88:91], v[8:11]
    ds_read_b64_tr_b16 v[144:145], v180 offset:40960
    v_mfma_f32_16x16x32_bf16 v[24:27], v[152:155], v[92:95], v[24:27]
    ds_read_b64_tr_b16 v[146:147], v180 offset:41984
    v_mfma_f32_16x16x32_bf16 v[28:31], v[156:159], v[92:95], v[28:31]
    ds_read_b64_tr_b16 v[148:149], v181 offset:40960
    v_mfma_f32_16x16x32_bf16 v[12:15], v[156:159], v[88:91], v[12:15]
    ds_read_b64_tr_b16 v[150:151], v181 offset:41984
    s_waitcnt lgkmcnt(8)
    v_mfma_f32_16x16x32_bf16 v[0:3], v[128:131], v[96:99], v[0:3]
    ds_read_b64_tr_b16 v[152:153], v182 offset:40960
    v_mfma_f32_16x16x32_bf16 v[16:19], v[128:131], v[100:103], v[16:19]
    ds_read_b64_tr_b16 v[154:155], v182 offset:41984
    v_mfma_f32_16x16x32_bf16 v[20:23], v[132:135], v[100:103], v[20:23]
    ds_read_b64_tr_b16 v[156:157], v183 offset:40960
    v_mfma_f32_16x16x32_bf16 v[4:7], v[132:135], v[96:99], v[4:7]
    ds_read_b64_tr_b16 v[158:159], v183 offset:41984
    s_waitcnt lgkmcnt(8)
    v_mfma_f32_16x16x32_bf16 v[8:11], v[136:139], v[96:99], v[8:11]
    ds_read_b64_tr_b16 v[128:129], v180 offset:49152
    v_mfma_f32_16x16x32_bf16 v[24:27], v[136:139], v[100:103], v[24:27]
    ds_read_b64_tr_b16 v[130:131], v180 offset:50176
    v_mfma_f32_16x16x32_bf16 v[28:31], v[140:143], v[100:103], v[28:31]
    ds_read_b64_tr_b16 v[132:133], v181 offset:49152
    v_mfma_f32_16x16x32_bf16 v[12:15], v[140:143], v[96:99], v[12:15]
    ds_read_b64_tr_b16 v[134:135], v181 offset:50176
    s_waitcnt lgkmcnt(8)
    v_mfma_f32_16x16x32_bf16 v[0:3], v[144:147], v[104:107], v[0:3]
    ds_read_b64_tr_b16 v[136:137], v182 offset:49152
    v_mfma_f32_16x16x32_bf16 v[16:19], v[144:147], v[108:111], v[16:19]
    ds_read_b64_tr_b16 v[138:139], v182 offset:50176
    v_mfma_f32_16x16x32_bf16 v[20:23], v[148:151], v[108:111], v[20:23]
    ds_read_b64_tr_b16 v[140:141], v183 offset:49152
    v_mfma_f32_16x16x32_bf16 v[4:7], v[148:151], v[104:107], v[4:7]
    ds_read_b64_tr_b16 v[142:143], v183 offset:50176
    s_waitcnt lgkmcnt(8)
    v_mfma_f32_16x16x32_bf16 v[8:11], v[152:155], v[104:107], v[8:11]
    ds_read_b64_tr_b16 v[144:145], v180 offset:57344
    v_mfma_f32_16x16x32_bf16 v[24:27], v[152:155], v[108:111], v[24:27]
    ds_read_b64_tr_b16 v[146:147], v180 offset:58368
    v_mfma_f32_16x16x32_bf16 v[28:31], v[156:159], v[108:111], v[28:31]
    ds_read_b64_tr_b16 v[148:149], v181 offset:57344
    v_mfma_f32_16x16x32_bf16 v[12:15], v[156:159], v[104:107], v[12:15]
    ds_read_b64_tr_b16 v[150:151], v181 offset:58368
    s_waitcnt lgkmcnt(8)
    v_mfma_f32_16x16x32_bf16 v[0:3], v[128:131], v[112:115], v[0:3]
    ds_read_b64_tr_b16 v[152:153], v182 offset:57344
    v_mfma_f32_16x16x32_bf16 v[16:19], v[128:131], v[116:119], v[16:19]
    ds_read_b64_tr_b16 v[154:155], v182 offset:58368
    v_mfma_f32_16x16x32_bf16 v[20:23], v[132:135], v[116:119], v[20:23]
    ds_read_b64_tr_b16 v[156:157], v183 offset:57344
    v_mfma_f32_16x16x32_bf16 v[4:7], v[132:135], v[112:115], v[4:7]
    ds_read_b64_tr_b16 v[158:159], v183 offset:58368
    s_waitcnt lgkmcnt(8)
    v_mfma_f32_16x16x32_bf16 v[8:11], v[136:139], v[112:115], v[8:11]
    v_mfma_f32_16x16x32_bf16 v[24:27], v[136:139], v[116:119], v[24:27]
    v_mov_b32 v196, 1
    s_waitcnt vmcnt(0)
    s_mov_b64 exec, 1
    global_store_dword v188, v196, s[10:11] sc1
    s_mov_b64 exec, -1
    v_mfma_f32_16x16x32_bf16 v[28:31], v[140:143], v[116:119], v[28:31]
    v_mfma_f32_16x16x32_bf16 v[12:15], v[140:143], v[112:115], v[12:15]
    s_waitcnt lgkmcnt(4)
    v_mfma_f32_16x16x32_bf16 v[0:3], v[144:147], v[120:123], v[0:3]
    v_mfma_f32_16x16x32_bf16 v[16:19], v[144:147], v[124:127], v[16:19]
    v_mfma_f32_16x16x32_bf16 v[20:23], v[148:151], v[124:127], v[20:23]
    v_mfma_f32_16x16x32_bf16 v[4:7], v[148:151], v[120:123], v[4:7]
    s_waitcnt lgkmcnt(0)
    v_mfma_f32_16x16x32_bf16 v[8:11], v[152:155], v[120:123], v[8:11]
    v_mfma_f32_16x16x32_bf16 v[24:27], v[152:155], v[124:127], v[24:27]
    v_mfma_f32_16x16x32_bf16 v[28:31], v[156:159], v[124:127], v[28:31]
    v_mfma_f32_16x16x32_bf16 v[12:15], v[156:159], v[120:123], v[12:15]
    global_load_dword v197, v189, s[10:11] sc1
    v_lshlrev_b32 v128, 16, v160
    v_and_b32 v129, 0xffff0000, v160
    v_pk_fma_f32 v[128:129], v[128:129], v[192:193], v[192:193] op_sel:[0,1,0] op_sel_hi:[1,1,0]
    v_pk_add_f32 v[0:1], v[0:1], v[128:129]
    v_lshlrev_b32 v128, 16, v161
    v_and_b32 v129, 0xffff0000, v161
    v_pk_fma_f32 v[128:129], v[128:129], v[192:193], v[192:193] op_sel:[0,1,0] op_sel_hi:[1,1,0]
    v_pk_add_f32 v[2:3], v[2:3], v[128:129]
    v_lshlrev_b32 v128, 16, v162
    v_and_b32 v129, 0xffff0000, v162
    v_pk_fma_f32 v[128:129], v[128:129], v[192:193], v[192:193] op_sel:[0,1,0] op_sel_hi:[1,1,0]
    v_pk_add_f32 v[4:5], v[4:5], v[128:129]
    v_lshlrev_b32 v128, 16, v163
    v_and_b32 v129, 0xffff0000, v163
    v_pk_fma_f32 v[128:129], v[128:129], v[192:193], v[192:193] op_sel:[0,1,0] op_sel_hi:[1,1,0]
    v_pk_add_f32 v[6:7], v[6:7], v[128:129]
    v_lshlrev_b32 v128, 16, v164
    v_and_b32 v129, 0xffff0000, v164
    v_pk_fma_f32 v[128:129], v[128:129], v[192:193], v[192:193] op_sel:[0,1,0] op_sel_hi:[1,1,0]
    v_pk_add_f32 v[8:9], v[8:9], v[128:129]
    v_lshlrev_b32 v128, 16, v165
    v_and_b32 v129, 0xffff0000, v165
    v_pk_fma_f32 v[128:129], v[128:129], v[192:193], v[192:193] op_sel:[0,1,0] op_sel_hi:[1,1,0]
    v_pk_add_f32 v[10:11], v[10:11], v[128:129]
    v_lshlrev_b32 v128, 16, v166
    v_and_b32 v129, 0xffff0000, v166
    v_pk_fma_f32 v[128:129], v[128:129], v[192:193], v[192:193] op_sel:[0,1,0] op_sel_hi:[1,1,0]
    v_pk_add_f32 v[12:13], v[12:13], v[128:129]
    v_lshlrev_b32 v128, 16, v167
    v_and_b32 v129, 0xffff0000, v167
    v_pk_fma_f32 v[128:129], v[128:129], v[192:193], v[192:193] op_sel:[0,1,0] op_sel_hi:[1,1,0]
    v_pk_add_f32 v[14:15], v[14:15], v[128:129]
    v_lshlrev_b32 v128, 16, v168
    v_and_b32 v129, 0xffff0000, v168
    v_pk_fma_f32 v[128:129], v[128:129], v[194:195], v[194:195] op_sel:[0,1,0] op_sel_hi:[1,1,0]
    v_pk_add_f32 v[16:17], v[16:17], v[128:129]
    v_lshlrev_b32 v128, 16, v169
    v_and_b32 v129, 0xffff0000, v169
    v_pk_fma_f32 v[128:129], v[128:129], v[194:195], v[194:195] op_sel:[0,1,0] op_sel_hi:[1,1,0]
    v_pk_add_f32 v[18:19], v[18:19], v[128:129]
    v_lshlrev_b32 v128, 16, v170
    v_and_b32 v129, 0xffff0000, v170
    v_pk_fma_f32 v[128:129], v[128:129], v[194:195], v[194:195] op_sel:[0,1,0] op_sel_hi:[1,1,0]
    v_pk_add_f32 v[20:21], v[20:21], v[128:129]
    v_lshlrev_b32 v128, 16, v171
    v_and_b32 v129, 0xffff0000, v171
    v_pk_fma_f32 v[128:129], v[128:129], v[194:195], v[194:195] op_sel:[0,1,0] op_sel_hi:[1,1,0]
    v_pk_add_f32 v[22:23], v[22:23], v[128:129]
    v_lshlrev_b32 v128, 16, v172
    v_and_b32 v129, 0xffff0000, v172
    v_pk_fma_f32 v[128:129], v[128:129], v[194:195], v[194:195] op_sel:[0,1,0] op_sel_hi:[1,1,0]
    v_pk_add_f32 v[24:25], v[24:25], v[128:129]
    v_lshlrev_b32 v128, 16, v173
    v_and_b32 v129, 0xffff0000, v173
    v_pk_fma_f32 v[128:129], v[128:129], v[194:195], v[194:195] op_sel:[0,1,0] op_sel_hi:[1,1,0]
    v_pk_add_f32 v[26:27], v[26:27], v[128:129]
    v_lshlrev_b32 v128, 16, v174
    v_and_b32 v129, 0xffff0000, v174
    v_pk_fma_f32 v[128:129], v[128:129], v[194:195], v[194:195] op_sel:[0,1,0] op_sel_hi:[1,1,0]
    v_pk_add_f32 v[28:29], v[28:29], v[128:129]
    v_lshlrev_b32 v128, 16, v175
    v_and_b32 v129, 0xffff0000, v175
    v_pk_fma_f32 v[128:129], v[128:129], v[194:195], v[194:195] op_sel:[0,1,0] op_sel_hi:[1,1,0]
    v_pk_add_f32 v[30:31], v[30:31], v[128:129]
    v_permlane16_swap_b32 v0, v4
    v_permlane16_swap_b32 v1, v5
    v_permlane16_swap_b32 v2, v6
    v_permlane16_swap_b32 v3, v7
    v_permlane16_swap_b32 v8, v12
    v_permlane16_swap_b32 v9, v13
    v_permlane16_swap_b32 v10, v14
    v_permlane16_swap_b32 v11, v15
    v_permlane16_swap_b32 v16, v20
    v_permlane16_swap_b32 v17, v21
    v_permlane16_swap_b32 v18, v22
    v_permlane16_swap_b32 v19, v23
    v_permlane16_swap_b32 v24, v28
    v_permlane16_swap_b32 v25, v29
    v_permlane16_swap_b32 v26, v30
    v_permlane16_swap_b32 v27, v31
    s_mov_b32 s63, 0x40000
sequential_preLN__spectral_gfnet__glu_gated_bilinear__prompt_kernel_xp:
    s_waitcnt vmcnt(0)
    v_cmp_ne_u32 vcc, 1, v197
    s_sub_u32 s63, s63, 1
    s_cbranch_scc1 sequential_preLN__spectral_gfnet__glu_gated_bilinear__prompt_kernel_xd
    s_cbranch_vccz sequential_preLN__spectral_gfnet__glu_gated_bilinear__prompt_kernel_xd
    s_sleep 2
    global_load_dword v197, v189, s[10:11] sc1
    s_branch sequential_preLN__spectral_gfnet__glu_gated_bilinear__prompt_kernel_xp
sequential_preLN__spectral_gfnet__glu_gated_bilinear__prompt_kernel_xd:
    buffer_load_dwordx4 v[64:67], v231, s[16:19], s31 offen offset:0 sc1
    buffer_load_dwordx4 v[68:71], v231, s[16:19], s31 offen offset:1024 sc1
    buffer_load_dwordx4 v[72:75], v231, s[16:19], s31 offen offset:2048 sc1
    buffer_load_dwordx4 v[76:79], v231, s[16:19], s31 offen offset:3072 sc1
    s_waitcnt vmcnt(3)
    v_lshlrev_b32 v128, 16, v64
    v_and_b32 v129, 0xffff0000, v64
    v_lshlrev_b32 v130, 16, v65
    v_and_b32 v131, 0xffff0000, v65
    v_lshlrev_b32 v132, 16, v66
    v_and_b32 v133, 0xffff0000, v66
    v_lshlrev_b32 v134, 16, v67
    v_and_b32 v135, 0xffff0000, v67
    v_pk_add_f32 v[0:1], v[0:1], v[128:129]
    v_pk_add_f32 v[2:3], v[2:3], v[130:131]
    v_pk_add_f32 v[4:5], v[4:5], v[132:133]
    v_pk_add_f32 v[6:7], v[6:7], v[134:135]
    v_cvt_pk_bf16_f32 v64, v0, v1
    v_cvt_pk_bf16_f32 v65, v2, v3
    v_cvt_pk_bf16_f32 v66, v4, v5
    v_cvt_pk_bf16_f32 v67, v6, v7
    buffer_store_dwordx4 v[64:67], v176, s[12:15], s27 offen offset:0 sc1
    s_waitcnt vmcnt(3)
    v_lshlrev_b32 v128, 16, v68
    v_and_b32 v129, 0xffff0000, v68
    v_lshlrev_b32 v130, 16, v69
    v_and_b32 v131, 0xffff0000, v69
    v_lshlrev_b32 v132, 16, v70
    v_and_b32 v133, 0xffff0000, v70
    v_lshlrev_b32 v134, 16, v71
    v_and_b32 v135, 0xffff0000, v71
    v_pk_add_f32 v[8:9], v[8:9], v[128:129]
    v_pk_add_f32 v[10:11], v[10:11], v[130:131]
    v_pk_add_f32 v[12:13], v[12:13], v[132:133]
    v_pk_add_f32 v[14:15], v[14:15], v[134:135]
    v_cvt_pk_bf16_f32 v68, v8, v9
    v_cvt_pk_bf16_f32 v69, v10, v11
    v_cvt_pk_bf16_f32 v70, v12, v13
    v_cvt_pk_bf16_f32 v71, v14, v15
    buffer_store_dwordx4 v[68:71], v176, s[12:15], s27 offen offset:64 sc1
    s_waitcnt vmcnt(3)
    v_lshlrev_b32 v128, 16, v72
    v_and_b32 v129, 0xffff0000, v72
    v_lshlrev_b32 v130, 16, v73
    v_and_b32 v131, 0xffff0000, v73
    v_lshlrev_b32 v132, 16, v74
    v_and_b32 v133, 0xffff0000, v74
    v_lshlrev_b32 v134, 16, v75
    v_and_b32 v135, 0xffff0000, v75
    v_pk_add_f32 v[16:17], v[16:17], v[128:129]
    v_pk_add_f32 v[18:19], v[18:19], v[130:131]
    v_pk_add_f32 v[20:21], v[20:21], v[132:133]
    v_pk_add_f32 v[22:23], v[22:23], v[134:135]
    v_cvt_pk_bf16_f32 v72, v16, v17
    v_cvt_pk_bf16_f32 v73, v18, v19
    v_cvt_pk_bf16_f32 v74, v20, v21
    v_cvt_pk_bf16_f32 v75, v22, v23
    buffer_store_dwordx4 v[72:75], v177, s[12:15], s27 offen offset:0 sc1
    s_waitcnt vmcnt(3)
    v_lshlrev_b32 v128, 16, v76
    v_and_b32 v129, 0xffff0000, v76
    v_lshlrev_b32 v130, 16, v77
    v_and_b32 v131, 0xffff0000, v77
    v_lshlrev_b32 v132, 16, v78
    v_and_b32 v133, 0xffff0000, v78
    v_lshlrev_b32 v134, 16, v79
    v_and_b32 v135, 0xffff0000, v79
    v_pk_add_f32 v[24:25], v[24:25], v[128:129]
    v_pk_add_f32 v[26:27], v[26:27], v[130:131]
    v_pk_add_f32 v[28:29], v[28:29], v[132:133]
    v_pk_add_f32 v[30:31], v[30:31], v[134:135]
    v_cvt_pk_bf16_f32 v76, v24, v25
    v_cvt_pk_bf16_f32 v77, v26, v27
    v_cvt_pk_bf16_f32 v78, v28, v29
    v_cvt_pk_bf16_f32 v79, v30, v31
    buffer_store_dwordx4 v[76:79], v177, s[12:15], s27 offen offset:64 sc1
    s_waitcnt vmcnt(0)
sequential_preLN__spectral_gfnet__glu_gated_bilinear__prompt_kernel_end:
    s_endpgm
code_end:
.section .rodata,"a"
.p2align 6
.amdhsa_kernel sequential_preLN__spectral_gfnet__glu_gated_bilinear__prompt_kernel
  .amdhsa_next_free_vgpr 336
  .amdhsa_next_free_sgpr 64
  .amdhsa_accum_offset 256
  .amdhsa_group_segment_fixed_size 0
  .amdhsa_kernarg_size 80
  .amdhsa_user_sgpr_count 2
  .amdhsa_user_sgpr_kernarg_segment_ptr 1
  .amdhsa_system_sgpr_workgroup_id_x 1
  .amdhsa_float_denorm_mode_32 3
.end_amdhsa_kernel
```
